```python
import torch

def _softmax(x, axis=-1):
    return torch.softmax(x, dim=axis)
def _gelu(x):
    return torch.nn.functional.gelu(x, approximate="tanh")
def _silu(x):
    return torch.nn.functional.silu(x)
def _sigmoid(x):
    return torch.sigmoid(x)
def _layernorm(x, axis=-1, eps=1e-5):
    m = x.mean(dim=axis, keepdim=True)
    v = x.var(dim=axis, keepdim=True, unbiased=False)
    return (x - m) / torch.sqrt(v + eps)
def _scatter_add(tgt, idx, src, axis=0):
    return tgt.clone().index_add_(axis, idx, src)
def _segment_sum(src, seg, n):
    out = torch.zeros((n,) + src.shape[1:], dtype=src.dtype)
    return out.index_add_(0, seg, src)
def _pad(x, pw):
    flat = tuple(v for pair in reversed(pw) for v in pair)
    return torch.nn.functional.pad(x, flat)

kernel_name = 'sequential_preLN__softmax_full_mha__dense_activation_relu__prompt'

def setup_inputs():

    _w = (lambda a: (lambda t: t.to(torch.bfloat16) if t.is_floating_point() else t)(torch.as_tensor(a)))
    def _A_setup():
        B, S, D = 1, 2048, 640
        return {
            "x": _w((lambda *s: torch.randn(*s, dtype=torch.bfloat16) * 0.05)(B, S, D)),
            "wqkv": _w((lambda *s: torch.randn(*s, dtype=torch.bfloat16) * 0.05)(D, 3 * D)),
            "wo": _w((lambda *s: torch.randn(*s, dtype=torch.bfloat16) * 0.05)(D, D)),
        }
    _A_in = _A_setup()

    def _B_setup():
        B, S, D, Dff = 1, 2048, 640, 1536
        return {
            "x": _w((lambda *s: torch.randn(*s, dtype=torch.bfloat16) * 0.05)(B, S, D)),
            "w1": _w((lambda *s: torch.randn(*s, dtype=torch.bfloat16) * 0.05)(D, Dff)),
            "w2": _w((lambda *s: torch.randn(*s, dtype=torch.bfloat16) * 0.05)(Dff, D)),
        }
    _B_in = _B_setup()

    return {
        "A_x": _A_in["x"],
        "A_wqkv": _A_in["wqkv"],
        "A_wo": _A_in["wo"],
        "B_x": _B_in["x"],
        "B_w1": _B_in["w1"],
        "B_w2": _B_in["w2"],
    }

def reference(A_x, A_wqkv, A_wo, B_x, B_w1, B_w2):
    def _A_ref(x, wqkv, wo):
        B, S, D = x.shape
        H = 32; Dh = D // H
        qkv = (lambda x, *d: x.permute(*d))((x @ wqkv).reshape(B, S, 3, H, Dh), 2, 0, 3, 1, 4)
        q, k, v = qkv[0], qkv[1], qkv[2]
        scale = Dh ** -0.5
        scores = torch.einsum("bhqd,bhkd->bhqk", q, k) * scale
        p = _softmax(scores, axis=-1)
        o = torch.einsum("bhqk,bhkd->bhqd", p, v)
        return (lambda x, *d: x.permute(*d))(o, 0, 2, 1, 3).reshape(B, S, D) @ wo

    def _B_ref(x, w1, w2):
        h = torch.einsum("bsd,df->bsf", x, w1)
        zero = torch.zeros_like(h)
        h = torch.maximum(h, zero)
        return torch.einsum("bsf,fd->bsd", h, w2)

    x = A_x
    h = x + _A_ref(_layernorm(x, axis=-1), A_wqkv, A_wo)
    h2 = h + _B_ref(_layernorm(h, axis=-1), B_w1, B_w2)
    return h2
```

```asm
; @launch kernel=qkv_kernel grid=(256,1,1) block=(512,1,1) lds=163840
; @launch kernel=fused_kernel grid=(256,1,1) block=(576,1,1) lds=163840
.amdgcn_target "amdgcn-amd-amdhsa--gfx950"
.text
.globl qkv_kernel
.p2align 8
.type qkv_kernel,@function
qkv_kernel:
    s_cmp_ge_u32 s2, 256
    s_cbranch_scc1 L_k1_end
    s_load_dwordx4 s[4:7], s[0:1], 0
    s_load_dwordx2 s[44:45], s[0:1], 64
    s_and_b32 s43, s2, 7
    s_lshr_b32 s42, s2, 3
    s_lshr_b32 s23, s43, 1
    s_lshl_b32 s23, s23, 2
    s_and_b32 s36, s42, 3
    s_add_u32 s23, s23, s36
    s_and_b32 s24, s43, 1
    s_lshl_b32 s24, s24, 3
    s_lshr_b32 s36, s42, 2
    s_add_u32 s36, s36, 7
    s_and_b32 s36, s36, 7
    s_add_u32 s24, s24, s36
    s_load_dwordx2 s[50:51], s[0:1], 56
    v_lshrrev_b32 v160, 6, v0
    v_and_b32 v1, 63, v0
    v_readfirstlane_b32 s20, v160
    v_lshrrev_b32 v162, 4, v1
    s_nop 1
    s_cmp_eq_u32 s24, 15
    s_cbranch_scc1 L_k1_stat
    s_cmp_lt_u32 s20, 4
    s_cbranch_scc1 L_k1_compute
    s_and_b32 s21, s20, 3
    s_lshl_b32 s33, s21, 12
    v_lshrrev_b32 v160, 3, v1
    v_mul_u32_u24 v160, 1280, v160
    v_and_b32 v161, 7, v1
    v_xor_b32 v161, v161, v162
    v_lshl_add_u32 v2, v161, 4, v160
    v_xor_b32 v3, 64, v2
    v_add_u32 v3, 9216, v3
    v_add_u32 v4, 18432, v2
    v_add_u32 v5, 18432, v3
    v_mul_u32_u24 v160, 3840, v162
    v_and_b32 v161, 15, v1
    v_lshlrev_b32 v163, 2, v162
    v_xor_b32 v161, v161, v163
    v_lshl_add_u32 v6, v161, 4, v160
    v_add_u32 v7, 14336, v6
    v_add_u32 v8, 28672, v6
    v_add_u32 v9, 43008, v6
    s_mul_i32 s29, s23, 163840
    s_mul_i32 s34, s21, 40960
    s_add_u32 s29, s29, s34
    s_lshl_b32 s30, s24, 8
    s_mul_i32 s34, s21, 61440
    s_add_u32 s30, s30, s34
    s_and_b32 s34, s42, 3
    s_lshr_b32 s35, s42, 2
    s_mul_i32 s34, s34, 3
    s_add_u32 s27, s34, s35
    s_sub_u32 s34, s27, 10
    s_cmp_ge_u32 s27, 10
    s_cmov_b32 s27, s34
    s_lshl_b32 s34, s27, 7
    s_add_u32 s29, s29, s34
    s_mul_i32 s34, s27, 245760
    s_add_u32 s30, s30, s34
    s_waitcnt lgkmcnt(0)
    s_mov_b32 s8, s4
    s_and_b32 s9, s5, 0xffff
    s_mov_b32 s10, 2621440
    s_mov_b32 s11, 0x20000
    s_mov_b32 s12, s6
    s_and_b32 s13, s7, 0xffff
    s_mov_b32 s14, 2457600
    s_mov_b32 s15, 0x20000
    s_add_u32 m0, s33, 0
    s_nop 0
    buffer_load_dwordx4 v2, s[8:11], s29 offen offset:0 lds
    buffer_load_dwordx4 v3, s[8:11], s29 offen offset:1024 lds
    buffer_load_dwordx4 v4, s[8:11], s29 offen offset:2048 lds
    buffer_load_dwordx4 v5, s[8:11], s29 offen offset:3072 lds
    s_add_u32 m0, m0, 16384
    s_add_u32 s29, s29, 128
    buffer_load_dwordx4 v6, s[12:15], s30 offen offset:0 lds
    buffer_load_dwordx4 v7, s[12:15], s30 offen offset:1024 lds
    buffer_load_dwordx4 v8, s[12:15], s30 offen offset:2048 lds
    buffer_load_dwordx4 v9, s[12:15], s30 offen offset:3072 lds
    s_add_u32 s30, s30, 245760
    s_add_u32 s27, s27, 1
    s_cmp_lg_u32 s27, 10
    s_cbranch_scc1 L_k1rot_1
    s_sub_u32 s29, s29, 1280
    s_sub_u32 s30, s30, 2457600
L_k1rot_1:
    s_add_u32 m0, s33, 32768
    s_nop 0
    buffer_load_dwordx4 v2, s[8:11], s29 offen offset:0 lds
    buffer_load_dwordx4 v3, s[8:11], s29 offen offset:1024 lds
    buffer_load_dwordx4 v4, s[8:11], s29 offen offset:2048 lds
    buffer_load_dwordx4 v5, s[8:11], s29 offen offset:3072 lds
    s_add_u32 m0, m0, 16384
    s_add_u32 s29, s29, 128
    buffer_load_dwordx4 v6, s[12:15], s30 offen offset:0 lds
    buffer_load_dwordx4 v7, s[12:15], s30 offen offset:1024 lds
    buffer_load_dwordx4 v8, s[12:15], s30 offen offset:2048 lds
    buffer_load_dwordx4 v9, s[12:15], s30 offen offset:3072 lds
    s_add_u32 s30, s30, 245760
    s_add_u32 s27, s27, 1
    s_cmp_lg_u32 s27, 10
    s_cbranch_scc1 L_k1rot_2
    s_sub_u32 s29, s29, 1280
    s_sub_u32 s30, s30, 2457600
L_k1rot_2:
    s_mov_b32 s16, s44
    s_and_b32 s17, s45, 0xffff
    s_mov_b32 s18, 27262976
    s_mov_b32 s19, 0x20000
    s_mov_b32 s52, s50
    s_and_b32 s53, s51, 0xffff
    s_mov_b32 s54, 256
    s_mov_b32 s55, 0x20000
    s_waitcnt vmcnt(8)
    s_barrier
    s_add_u32 m0, s33, 65536
    s_nop 0
    buffer_load_dwordx4 v2, s[8:11], s29 offen offset:0 lds
    buffer_load_dwordx4 v3, s[8:11], s29 offen offset:1024 lds
    buffer_load_dwordx4 v4, s[8:11], s29 offen offset:2048 lds
    buffer_load_dwordx4 v5, s[8:11], s29 offen offset:3072 lds
    s_add_u32 m0, m0, 16384
    s_add_u32 s29, s29, 128
    buffer_load_dwordx4 v6, s[12:15], s30 offen offset:0 lds
    buffer_load_dwordx4 v7, s[12:15], s30 offen offset:1024 lds
    buffer_load_dwordx4 v8, s[12:15], s30 offen offset:2048 lds
    buffer_load_dwordx4 v9, s[12:15], s30 offen offset:3072 lds
    s_add_u32 s30, s30, 245760
    s_add_u32 s27, s27, 1
    s_cmp_lg_u32 s27, 10
    s_cbranch_scc1 L_k1rot_3
    s_sub_u32 s29, s29, 1280
    s_sub_u32 s30, s30, 2457600
L_k1rot_3:
    s_waitcnt vmcnt(8)
    s_barrier
    s_add_u32 m0, s33, 98304
    s_nop 0
    buffer_load_dwordx4 v2, s[8:11], s29 offen offset:0 lds
    buffer_load_dwordx4 v3, s[8:11], s29 offen offset:1024 lds
    buffer_load_dwordx4 v4, s[8:11], s29 offen offset:2048 lds
    buffer_load_dwordx4 v5, s[8:11], s29 offen offset:3072 lds
    s_add_u32 m0, m0, 16384
    s_add_u32 s29, s29, 128
    buffer_load_dwordx4 v6, s[12:15], s30 offen offset:0 lds
    buffer_load_dwordx4 v7, s[12:15], s30 offen offset:1024 lds
    buffer_load_dwordx4 v8, s[12:15], s30 offen offset:2048 lds
    buffer_load_dwordx4 v9, s[12:15], s30 offen offset:3072 lds
    s_add_u32 s30, s30, 245760
    s_add_u32 s27, s27, 1
    s_cmp_lg_u32 s27, 10
    s_cbranch_scc1 L_k1rot_4
    s_sub_u32 s29, s29, 1280
    s_sub_u32 s30, s30, 2457600
L_k1rot_4:
    s_waitcnt vmcnt(8)
    s_barrier
    s_add_u32 m0, s33, 131072
    s_nop 0
    buffer_load_dwordx4 v2, s[8:11], s29 offen offset:0 lds
    buffer_load_dwordx4 v3, s[8:11], s29 offen offset:1024 lds
    buffer_load_dwordx4 v4, s[8:11], s29 offen offset:2048 lds
    buffer_load_dwordx4 v5, s[8:11], s29 offen offset:3072 lds
    s_add_u32 m0, m0, 16384
    s_add_u32 s29, s29, 128
    buffer_load_dwordx4 v6, s[12:15], s30 offen offset:0 lds
    buffer_load_dwordx4 v7, s[12:15], s30 offen offset:1024 lds
    buffer_load_dwordx4 v8, s[12:15], s30 offen offset:2048 lds
    buffer_load_dwordx4 v9, s[12:15], s30 offen offset:3072 lds
    s_add_u32 s30, s30, 245760
    s_add_u32 s27, s27, 1
    s_cmp_lg_u32 s27, 10
    s_cbranch_scc1 L_k1rot_5
    s_sub_u32 s29, s29, 1280
    s_sub_u32 s30, s30, 2457600
L_k1rot_5:
    s_waitcnt vmcnt(8)
    s_barrier
    s_add_u32 m0, s33, 0
    s_nop 0
    buffer_load_dwordx4 v2, s[8:11], s29 offen offset:0 lds
    buffer_load_dwordx4 v3, s[8:11], s29 offen offset:1024 lds
    buffer_load_dwordx4 v4, s[8:11], s29 offen offset:2048 lds
    buffer_load_dwordx4 v5, s[8:11], s29 offen offset:3072 lds
    s_add_u32 m0, m0, 16384
    s_add_u32 s29, s29, 128
    buffer_load_dwordx4 v6, s[12:15], s30 offen offset:0 lds
    buffer_load_dwordx4 v7, s[12:15], s30 offen offset:1024 lds
    buffer_load_dwordx4 v8, s[12:15], s30 offen offset:2048 lds
    buffer_load_dwordx4 v9, s[12:15], s30 offen offset:3072 lds
    s_add_u32 s30, s30, 245760
    s_add_u32 s27, s27, 1
    s_cmp_lg_u32 s27, 10
    s_cbranch_scc1 L_k1rot_6
    s_sub_u32 s29, s29, 1280
    s_sub_u32 s30, s30, 2457600
L_k1rot_6:
    s_waitcnt vmcnt(8)
    s_barrier
    s_add_u32 m0, s33, 32768
    s_nop 0
    buffer_load_dwordx4 v2, s[8:11], s29 offen offset:0 lds
    buffer_load_dwordx4 v3, s[8:11], s29 offen offset:1024 lds
    buffer_load_dwordx4 v4, s[8:11], s29 offen offset:2048 lds
    buffer_load_dwordx4 v5, s[8:11], s29 offen offset:3072 lds
    s_add_u32 m0, m0, 16384
    s_add_u32 s29, s29, 128
    buffer_load_dwordx4 v6, s[12:15], s30 offen offset:0 lds
    buffer_load_dwordx4 v7, s[12:15], s30 offen offset:1024 lds
    buffer_load_dwordx4 v8, s[12:15], s30 offen offset:2048 lds
    buffer_load_dwordx4 v9, s[12:15], s30 offen offset:3072 lds
    s_add_u32 s30, s30, 245760
    s_add_u32 s27, s27, 1
    s_cmp_lg_u32 s27, 10
    s_cbranch_scc1 L_k1rot_7
    s_sub_u32 s29, s29, 1280
    s_sub_u32 s30, s30, 2457600
L_k1rot_7:
    s_waitcnt vmcnt(8)
    s_barrier
    s_add_u32 m0, s33, 65536
    s_nop 0
    buffer_load_dwordx4 v2, s[8:11], s29 offen offset:0 lds
    buffer_load_dwordx4 v3, s[8:11], s29 offen offset:1024 lds
    buffer_load_dwordx4 v4, s[8:11], s29 offen offset:2048 lds
    buffer_load_dwordx4 v5, s[8:11], s29 offen offset:3072 lds
    s_add_u32 m0, m0, 16384
    s_add_u32 s29, s29, 128
    buffer_load_dwordx4 v6, s[12:15], s30 offen offset:0 lds
    buffer_load_dwordx4 v7, s[12:15], s30 offen offset:1024 lds
    buffer_load_dwordx4 v8, s[12:15], s30 offen offset:2048 lds
    buffer_load_dwordx4 v9, s[12:15], s30 offen offset:3072 lds
    s_add_u32 s30, s30, 245760
    s_add_u32 s27, s27, 1
    s_cmp_lg_u32 s27, 10
    s_cbranch_scc1 L_k1rot_8
    s_sub_u32 s29, s29, 1280
    s_sub_u32 s30, s30, 2457600
L_k1rot_8:
    s_waitcnt vmcnt(8)
    s_barrier
    s_add_u32 m0, s33, 98304
    s_nop 0
    buffer_load_dwordx4 v2, s[8:11], s29 offen offset:0 lds
    buffer_load_dwordx4 v3, s[8:11], s29 offen offset:1024 lds
    buffer_load_dwordx4 v4, s[8:11], s29 offen offset:2048 lds
    buffer_load_dwordx4 v5, s[8:11], s29 offen offset:3072 lds
    s_add_u32 m0, m0, 16384
    s_add_u32 s29, s29, 128
    buffer_load_dwordx4 v6, s[12:15], s30 offen offset:0 lds
    buffer_load_dwordx4 v7, s[12:15], s30 offen offset:1024 lds
    buffer_load_dwordx4 v8, s[12:15], s30 offen offset:2048 lds
    buffer_load_dwordx4 v9, s[12:15], s30 offen offset:3072 lds
    s_add_u32 s30, s30, 245760
    s_add_u32 s27, s27, 1
    s_cmp_lg_u32 s27, 10
    s_cbranch_scc1 L_k1rot_9
    s_sub_u32 s29, s29, 1280
    s_sub_u32 s30, s30, 2457600
L_k1rot_9:
    s_waitcnt vmcnt(8)
    s_barrier
    s_add_u32 m0, s33, 131072
    s_nop 0
    buffer_load_dwordx4 v2, s[8:11], s29 offen offset:0 lds
    buffer_load_dwordx4 v3, s[8:11], s29 offen offset:1024 lds
    buffer_load_dwordx4 v4, s[8:11], s29 offen offset:2048 lds
    buffer_load_dwordx4 v5, s[8:11], s29 offen offset:3072 lds
    s_add_u32 m0, m0, 16384
    s_add_u32 s29, s29, 128
    buffer_load_dwordx4 v6, s[12:15], s30 offen offset:0 lds
    buffer_load_dwordx4 v7, s[12:15], s30 offen offset:1024 lds
    buffer_load_dwordx4 v8, s[12:15], s30 offen offset:2048 lds
    buffer_load_dwordx4 v9, s[12:15], s30 offen offset:3072 lds
    s_add_u32 s30, s30, 245760
    s_add_u32 s27, s27, 1
    s_cmp_lg_u32 s27, 10
    s_cbranch_scc1 L_k1rot_10
    s_sub_u32 s29, s29, 1280
    s_sub_u32 s30, s30, 2457600
L_k1rot_10:
    s_waitcnt vmcnt(8)
    s_barrier
    s_cmp_lg_u32 s21, 0
    s_cbranch_scc1 L_k1_nost
    s_lshl_b32 s34, s23, 2
    v_mov_b32 v160, 0
    s_mov_b32 s35, 200000
L_k1_polls:
    buffer_load_dword v161, v160, s[52:55], s34 offen sc1
    s_waitcnt vmcnt(0)
    v_cmp_ne_u32 vcc, 1, v161
    s_sub_u32 s35, s35, 1
    s_cbranch_vccz L_k1_pollds
    s_cbranch_scc1 L_k1_pollds
    s_sleep 1
    s_branch L_k1_polls
L_k1_pollds:
    s_lshl_b32 s34, s23, 10
    s_add_u32 s34, s34, 25755648
    v_lshlrev_b32 v160, 4, v1
    buffer_load_dwordx4 v[12:15], v160, s[16:19], s34 offen sc1
L_k1_nost:
    s_waitcnt vmcnt(0)
    s_barrier
    s_cmp_lg_u32 s21, 0
    s_cbranch_scc1 L_k1_nost2
    v_add_u32 v160, 65536, v160
    ds_write_b128 v160, v[12:15]
    s_waitcnt lgkmcnt(0)
L_k1_nost2:
    s_barrier
    s_barrier
    s_branch L_k1_fin
L_k1_stat:
    v_lshrrev_b32 v160, 3, v1
    v_mul_u32_u24 v161, 1280, v160
    v_and_b32 v162, 7, v1
    v_lshl_add_u32 v161, v162, 4, v161
    s_mul_i32 s29, s23, 163840
    s_mul_i32 s34, s20, 20480
    s_add_u32 s29, s29, s34
    s_add_u32 s30, s29, 10240
    v_mov_b32 v4, 0
    v_mov_b32 v5, 0
    v_mov_b32 v6, 0
    v_mov_b32 v7, 0
    s_mov_b32 s46, 0x3f803f80
    s_waitcnt lgkmcnt(0)
    s_mov_b32 s8, s4
    s_and_b32 s9, s5, 0xffff
    s_mov_b32 s10, 2621440
    s_mov_b32 s11, 0x20000
    s_mov_b32 s16, s44
    s_and_b32 s17, s45, 0xffff
    s_mov_b32 s18, 27262976
    s_mov_b32 s19, 0x20000
    s_mov_b32 s52, s50
    s_and_b32 s53, s51, 0xffff
    s_mov_b32 s54, 256
    s_mov_b32 s55, 0x20000
    buffer_load_dwordx4 v[16:19], v161, s[8:11], s29 offen offset:0
    buffer_load_dwordx4 v[20:23], v161, s[8:11], s30 offen offset:0
    buffer_load_dwordx4 v[24:27], v161, s[8:11], s29 offen offset:128
    buffer_load_dwordx4 v[28:31], v161, s[8:11], s30 offen offset:128
    buffer_load_dwordx4 v[32:35], v161, s[8:11], s29 offen offset:256
    buffer_load_dwordx4 v[36:39], v161, s[8:11], s30 offen offset:256
    buffer_load_dwordx4 v[40:43], v161, s[8:11], s29 offen offset:384
    buffer_load_dwordx4 v[44:47], v161, s[8:11], s30 offen offset:384
    buffer_load_dwordx4 v[48:51], v161, s[8:11], s29 offen offset:512
    buffer_load_dwordx4 v[52:55], v161, s[8:11], s30 offen offset:512
    buffer_load_dwordx4 v[56:59], v161, s[8:11], s29 offen offset:640
    buffer_load_dwordx4 v[60:63], v161, s[8:11], s30 offen offset:640
    buffer_load_dwordx4 v[64:67], v161, s[8:11], s29 offen offset:768
    buffer_load_dwordx4 v[68:71], v161, s[8:11], s30 offen offset:768
    buffer_load_dwordx4 v[72:75], v161, s[8:11], s29 offen offset:896
    buffer_load_dwordx4 v[76:79], v161, s[8:11], s30 offen offset:896
    buffer_load_dwordx4 v[80:83], v161, s[8:11], s29 offen offset:1024
    buffer_load_dwordx4 v[84:87], v161, s[8:11], s30 offen offset:1024
    buffer_load_dwordx4 v[88:91], v161, s[8:11], s29 offen offset:1152
    buffer_load_dwordx4 v[92:95], v161, s[8:11], s30 offen offset:1152
    s_mul_i32 s34, s2, 384
    s_add_u32 s34, s34, 26214400
    v_lshlrev_b32 v163, 4, v1
    s_mov_b64 exec, 0xffffff
    buffer_store_dwordx4 v[4:7], v163, s[16:19], s34 offen
    s_mov_b64 exec, -1
    s_nop 1
    s_waitcnt vmcnt(20)
    v_dot2c_f32_bf16 v4, s46, v16
    v_dot2c_f32_bf16 v6, v16, v16
    v_dot2c_f32_bf16 v4, s46, v17
    v_dot2c_f32_bf16 v6, v17, v17
    v_dot2c_f32_bf16 v4, s46, v18
    v_dot2c_f32_bf16 v6, v18, v18
    v_dot2c_f32_bf16 v4, s46, v19
    v_dot2c_f32_bf16 v6, v19, v19
    s_waitcnt vmcnt(19)
    v_dot2c_f32_bf16 v5, s46, v20
    v_dot2c_f32_bf16 v7, v20, v20
    v_dot2c_f32_bf16 v5, s46, v21
    v_dot2c_f32_bf16 v7, v21, v21
    v_dot2c_f32_bf16 v5, s46, v22
    v_dot2c_f32_bf16 v7, v22, v22
    v_dot2c_f32_bf16 v5, s46, v23
    v_dot2c_f32_bf16 v7, v23, v23
    s_waitcnt vmcnt(18)
    v_dot2c_f32_bf16 v4, s46, v24
    v_dot2c_f32_bf16 v6, v24, v24
    v_dot2c_f32_bf16 v4, s46, v25
    v_dot2c_f32_bf16 v6, v25, v25
    v_dot2c_f32_bf16 v4, s46, v26
    v_dot2c_f32_bf16 v6, v26, v26
    v_dot2c_f32_bf16 v4, s46, v27
    v_dot2c_f32_bf16 v6, v27, v27
    s_waitcnt vmcnt(17)
    v_dot2c_f32_bf16 v5, s46, v28
    v_dot2c_f32_bf16 v7, v28, v28
    v_dot2c_f32_bf16 v5, s46, v29
    v_dot2c_f32_bf16 v7, v29, v29
    v_dot2c_f32_bf16 v5, s46, v30
    v_dot2c_f32_bf16 v7, v30, v30
    v_dot2c_f32_bf16 v5, s46, v31
    v_dot2c_f32_bf16 v7, v31, v31
    s_waitcnt vmcnt(16)
    v_dot2c_f32_bf16 v4, s46, v32
    v_dot2c_f32_bf16 v6, v32, v32
    v_dot2c_f32_bf16 v4, s46, v33
    v_dot2c_f32_bf16 v6, v33, v33
    v_dot2c_f32_bf16 v4, s46, v34
    v_dot2c_f32_bf16 v6, v34, v34
    v_dot2c_f32_bf16 v4, s46, v35
    v_dot2c_f32_bf16 v6, v35, v35
    s_waitcnt vmcnt(15)
    v_dot2c_f32_bf16 v5, s46, v36
    v_dot2c_f32_bf16 v7, v36, v36
    v_dot2c_f32_bf16 v5, s46, v37
    v_dot2c_f32_bf16 v7, v37, v37
    v_dot2c_f32_bf16 v5, s46, v38
    v_dot2c_f32_bf16 v7, v38, v38
    v_dot2c_f32_bf16 v5, s46, v39
    v_dot2c_f32_bf16 v7, v39, v39
    s_waitcnt vmcnt(14)
    v_dot2c_f32_bf16 v4, s46, v40
    v_dot2c_f32_bf16 v6, v40, v40
    v_dot2c_f32_bf16 v4, s46, v41
    v_dot2c_f32_bf16 v6, v41, v41
    v_dot2c_f32_bf16 v4, s46, v42
    v_dot2c_f32_bf16 v6, v42, v42
    v_dot2c_f32_bf16 v4, s46, v43
    v_dot2c_f32_bf16 v6, v43, v43
    s_waitcnt vmcnt(13)
    v_dot2c_f32_bf16 v5, s46, v44
    v_dot2c_f32_bf16 v7, v44, v44
    v_dot2c_f32_bf16 v5, s46, v45
    v_dot2c_f32_bf16 v7, v45, v45
    v_dot2c_f32_bf16 v5, s46, v46
    v_dot2c_f32_bf16 v7, v46, v46
    v_dot2c_f32_bf16 v5, s46, v47
    v_dot2c_f32_bf16 v7, v47, v47
    s_waitcnt vmcnt(12)
    v_dot2c_f32_bf16 v4, s46, v48
    v_dot2c_f32_bf16 v6, v48, v48
    v_dot2c_f32_bf16 v4, s46, v49
    v_dot2c_f32_bf16 v6, v49, v49
    v_dot2c_f32_bf16 v4, s46, v50
    v_dot2c_f32_bf16 v6, v50, v50
    v_dot2c_f32_bf16 v4, s46, v51
    v_dot2c_f32_bf16 v6, v51, v51
    s_waitcnt vmcnt(11)
    v_dot2c_f32_bf16 v5, s46, v52
    v_dot2c_f32_bf16 v7, v52, v52
    v_dot2c_f32_bf16 v5, s46, v53
    v_dot2c_f32_bf16 v7, v53, v53
    v_dot2c_f32_bf16 v5, s46, v54
    v_dot2c_f32_bf16 v7, v54, v54
    v_dot2c_f32_bf16 v5, s46, v55
    v_dot2c_f32_bf16 v7, v55, v55
    s_waitcnt vmcnt(10)
    v_dot2c_f32_bf16 v4, s46, v56
    v_dot2c_f32_bf16 v6, v56, v56
    v_dot2c_f32_bf16 v4, s46, v57
    v_dot2c_f32_bf16 v6, v57, v57
    v_dot2c_f32_bf16 v4, s46, v58
    v_dot2c_f32_bf16 v6, v58, v58
    v_dot2c_f32_bf16 v4, s46, v59
    v_dot2c_f32_bf16 v6, v59, v59
    s_waitcnt vmcnt(9)
    v_dot2c_f32_bf16 v5, s46, v60
    v_dot2c_f32_bf16 v7, v60, v60
    v_dot2c_f32_bf16 v5, s46, v61
    v_dot2c_f32_bf16 v7, v61, v61
    v_dot2c_f32_bf16 v5, s46, v62
    v_dot2c_f32_bf16 v7, v62, v62
    v_dot2c_f32_bf16 v5, s46, v63
    v_dot2c_f32_bf16 v7, v63, v63
    s_waitcnt vmcnt(8)
    v_dot2c_f32_bf16 v4, s46, v64
    v_dot2c_f32_bf16 v6, v64, v64
    v_dot2c_f32_bf16 v4, s46, v65
    v_dot2c_f32_bf16 v6, v65, v65
    v_dot2c_f32_bf16 v4, s46, v66
    v_dot2c_f32_bf16 v6, v66, v66
    v_dot2c_f32_bf16 v4, s46, v67
    v_dot2c_f32_bf16 v6, v67, v67
    s_waitcnt vmcnt(7)
    v_dot2c_f32_bf16 v5, s46, v68
    v_dot2c_f32_bf16 v7, v68, v68
    v_dot2c_f32_bf16 v5, s46, v69
    v_dot2c_f32_bf16 v7, v69, v69
    v_dot2c_f32_bf16 v5, s46, v70
    v_dot2c_f32_bf16 v7, v70, v70
    v_dot2c_f32_bf16 v5, s46, v71
    v_dot2c_f32_bf16 v7, v71, v71
    s_waitcnt vmcnt(6)
    v_dot2c_f32_bf16 v4, s46, v72
    v_dot2c_f32_bf16 v6, v72, v72
    v_dot2c_f32_bf16 v4, s46, v73
    v_dot2c_f32_bf16 v6, v73, v73
    v_dot2c_f32_bf16 v4, s46, v74
    v_dot2c_f32_bf16 v6, v74, v74
    v_dot2c_f32_bf16 v4, s46, v75
    v_dot2c_f32_bf16 v6, v75, v75
    s_waitcnt vmcnt(5)
    v_dot2c_f32_bf16 v5, s46, v76
    v_dot2c_f32_bf16 v7, v76, v76
    v_dot2c_f32_bf16 v5, s46, v77
    v_dot2c_f32_bf16 v7, v77, v77
    v_dot2c_f32_bf16 v5, s46, v78
    v_dot2c_f32_bf16 v7, v78, v78
    v_dot2c_f32_bf16 v5, s46, v79
    v_dot2c_f32_bf16 v7, v79, v79
    s_waitcnt vmcnt(4)
    v_dot2c_f32_bf16 v4, s46, v80
    v_dot2c_f32_bf16 v6, v80, v80
    v_dot2c_f32_bf16 v4, s46, v81
    v_dot2c_f32_bf16 v6, v81, v81
    v_dot2c_f32_bf16 v4, s46, v82
    v_dot2c_f32_bf16 v6, v82, v82
    v_dot2c_f32_bf16 v4, s46, v83
    v_dot2c_f32_bf16 v6, v83, v83
    s_waitcnt vmcnt(3)
    v_dot2c_f32_bf16 v5, s46, v84
    v_dot2c_f32_bf16 v7, v84, v84
    v_dot2c_f32_bf16 v5, s46, v85
    v_dot2c_f32_bf16 v7, v85, v85
    v_dot2c_f32_bf16 v5, s46, v86
    v_dot2c_f32_bf16 v7, v86, v86
    v_dot2c_f32_bf16 v5, s46, v87
    v_dot2c_f32_bf16 v7, v87, v87
    s_waitcnt vmcnt(2)
    v_dot2c_f32_bf16 v4, s46, v88
    v_dot2c_f32_bf16 v6, v88, v88
    v_dot2c_f32_bf16 v4, s46, v89
    v_dot2c_f32_bf16 v6, v89, v89
    v_dot2c_f32_bf16 v4, s46, v90
    v_dot2c_f32_bf16 v6, v90, v90
    v_dot2c_f32_bf16 v4, s46, v91
    v_dot2c_f32_bf16 v6, v91, v91
    s_waitcnt vmcnt(1)
    v_dot2c_f32_bf16 v5, s46, v92
    v_dot2c_f32_bf16 v7, v92, v92
    v_dot2c_f32_bf16 v5, s46, v93
    v_dot2c_f32_bf16 v7, v93, v93
    v_dot2c_f32_bf16 v5, s46, v94
    v_dot2c_f32_bf16 v7, v94, v94
    v_dot2c_f32_bf16 v5, s46, v95
    v_dot2c_f32_bf16 v7, v95, v95
    s_nop 2
    s_nop 1
    v_add_f32_dpp v4, v4, v4 quad_perm:[1,0,3,2] row_mask:0xf bank_mask:0xf
    v_add_f32_dpp v5, v5, v5 quad_perm:[1,0,3,2] row_mask:0xf bank_mask:0xf
    v_add_f32_dpp v6, v6, v6 quad_perm:[1,0,3,2] row_mask:0xf bank_mask:0xf
    v_add_f32_dpp v7, v7, v7 quad_perm:[1,0,3,2] row_mask:0xf bank_mask:0xf
    s_nop 1
    v_add_f32_dpp v4, v4, v4 quad_perm:[2,3,0,1] row_mask:0xf bank_mask:0xf
    v_add_f32_dpp v5, v5, v5 quad_perm:[2,3,0,1] row_mask:0xf bank_mask:0xf
    v_add_f32_dpp v6, v6, v6 quad_perm:[2,3,0,1] row_mask:0xf bank_mask:0xf
    v_add_f32_dpp v7, v7, v7 quad_perm:[2,3,0,1] row_mask:0xf bank_mask:0xf
    s_nop 1
    v_add_f32_dpp v4, v4, v4 row_half_mirror row_mask:0xf bank_mask:0xf
    v_add_f32_dpp v5, v5, v5 row_half_mirror row_mask:0xf bank_mask:0xf
    v_add_f32_dpp v6, v6, v6 row_half_mirror row_mask:0xf bank_mask:0xf
    v_add_f32_dpp v7, v7, v7 row_half_mirror row_mask:0xf bank_mask:0xf
    v_and_b32 v162, 1, v1
    v_cmp_eq_u32 vcc, 1, v162
    v_lshl_add_u32 v160, v162, 3, v160
    v_lshlrev_b32 v160, 2, v160
    v_cndmask_b32 v4, v4, v5, vcc
    v_cndmask_b32 v6, v6, v7, vcc
    v_mul_f32 v10, 0x3acccccd, v4
    v_mul_f32 v12, 0x3acccccd, v6
    v_fma_f32 v12, -v10, v10, v12
    v_max_f32 v12, 0, v12
    v_cvt_pk_bf16_f32 v10, v10, v10
    v_lshlrev_b32 v10, 16, v10
    v_cvt_pk_bf16_f32 v12, v12, v12
    v_lshlrev_b32 v12, 16, v12
    v_add_f32 v12, 0x3727c5ac, v12
    v_cvt_pk_bf16_f32 v12, v12, v12
    v_lshlrev_b32 v12, 16, v12
    v_sqrt_f32 v12, v12
    s_nop 0
    v_cvt_pk_bf16_f32 v12, v12, v12
    v_lshlrev_b32 v12, 16, v12
    v_rcp_f32 v11, v12
    s_nop 0
    s_lshl_b32 s35, s20, 6
    v_add_u32 v160, s35, v160
    ds_write_b32 v160, v10
    ds_write_b32 v160, v11 offset:512
    v_mov_b32 v12, 0
    v_mov_b32 v13, 1
    s_lshl_b32 s35, s23, 10
    s_add_u32 s35, s35, 25755648
    s_lshl_b32 s34, s23, 2
    s_waitcnt lgkmcnt(0)
    s_barrier
    s_cmp_lg_u32 s20, 0
    s_cbranch_scc1 L_k1_fin
    ds_read_b128 v[16:19], v163
    s_waitcnt lgkmcnt(0)
    buffer_store_dwordx4 v[16:19], v163, s[16:19], s35 offen sc1
    s_waitcnt vmcnt(0)
    s_mov_b64 exec, 1
    buffer_store_dword v13, v12, s[52:55], s34 offen sc1
    s_mov_b64 exec, -1
    s_branch L_k1_fin
L_k1_compute:
    s_lshl_b32 s48, s42, 2
    s_add_u32 s48, s48, s20
    s_lshr_b32 s47, s43, 1
    s_lshl_b32 s47, s47, 7
    s_add_u32 s47, s47, s48
    s_mul_i32 s47, s47, 5120
    s_add_u32 s48, s48, 64
    s_mul_i32 s48, s48, 3840
    s_and_b32 s36, s43, 1
    s_lshl_b32 s36, s36, 11
    s_add_u32 s48, s48, s36
    v_lshlrev_b32 v29, 7, v1
    v_mov_b32 v96, 0
    v_mov_b32 v97, 0
    v_mov_b32 v98, 0
    v_mov_b32 v99, 0
    v_mov_b32 v100, 0
    v_mov_b32 v101, 0
    v_mov_b32 v102, 0
    v_mov_b32 v103, 0
    v_mov_b32 v104, 0
    v_mov_b32 v105, 0
    v_mov_b32 v106, 0
    v_mov_b32 v107, 0
    v_mov_b32 v108, 0
    v_mov_b32 v109, 0
    v_mov_b32 v110, 0
    v_mov_b32 v111, 0
    v_mov_b32 v112, 0
    v_mov_b32 v113, 0
    v_mov_b32 v114, 0
    v_mov_b32 v115, 0
    v_mov_b32 v116, 0
    v_mov_b32 v117, 0
    v_mov_b32 v118, 0
    v_mov_b32 v119, 0
    v_mov_b32 v120, 0
    v_mov_b32 v121, 0
    v_mov_b32 v122, 0
    v_mov_b32 v123, 0
    v_mov_b32 v124, 0
    v_mov_b32 v125, 0
    v_mov_b32 v126, 0
    v_mov_b32 v127, 0
    v_mov_b32 v128, 0
    v_mov_b32 v129, 0
    v_mov_b32 v130, 0
    v_mov_b32 v131, 0
    v_mov_b32 v132, 0
    v_mov_b32 v133, 0
    v_mov_b32 v134, 0
    v_mov_b32 v135, 0
    v_mov_b32 v136, 0
    v_mov_b32 v137, 0
    v_mov_b32 v138, 0
    v_mov_b32 v139, 0
    v_mov_b32 v140, 0
    v_mov_b32 v141, 0
    v_mov_b32 v142, 0
    v_mov_b32 v143, 0
    v_mov_b32 v144, 0
    v_mov_b32 v145, 0
    v_mov_b32 v146, 0
    v_mov_b32 v147, 0
    v_mov_b32 v148, 0
    v_mov_b32 v149, 0
    v_mov_b32 v150, 0
    v_mov_b32 v151, 0
    v_mov_b32 v152, 0
    v_mov_b32 v153, 0
    v_mov_b32 v154, 0
    v_mov_b32 v155, 0
    v_mov_b32 v156, 0
    v_mov_b32 v157, 0
    v_mov_b32 v158, 0
    v_mov_b32 v159, 0
    s_lshr_b32 s21, s20, 1
    s_and_b32 s22, s20, 1
    v_and_b32 v8, 31, v1
    v_lshrrev_b32 v9, 5, v1
    v_bfe_u32 v160, v8, 1, 3
    v_xor_b32 v160, v160, v9
    s_lshl_b32 s34, s21, 13
    v_lshlrev_b32 v161, 7, v8
    v_add_u32 v161, s34, v161
    v_xor_b32 v162, 0, v160
    v_lshl_add_u32 v2, v162, 4, v161
    v_xor_b32 v162, 2, v160
    v_lshl_add_u32 v3, v162, 4, v161
    v_xor_b32 v162, 4, v160
    v_lshl_add_u32 v4, v162, 4, v161
    v_xor_b32 v162, 6, v160
    v_lshl_add_u32 v5, v162, 4, v161
    v_bfe_u32 v160, v1, 2, 2
    v_lshl_add_u32 v161, v9, 3, v160
    v_lshlrev_b32 v161, 8, v161
    s_lshl_b32 s34, s22, 1
    s_add_u32 s34, s34, s21
    v_xor_b32 v162, s34, v160
    v_lshl_add_u32 v161, v162, 6, v161
    v_bfe_u32 v162, v1, 4, 1
    v_lshl_add_u32 v161, v162, 5, v161
    v_and_b32 v162, 3, v1
    v_lshl_add_u32 v161, v162, 3, v161
    v_add_u32 v6, 16384, v161
    v_xor_b32 v7, 64, v6
    v_mov_b32 v16, 0
    v_mov_b32 v17, 0
    v_mov_b32 v18, 0
    v_mov_b32 v19, 0
    v_lshrrev_b32 v160, 4, v1
    v_xor_b32 v160, v160, v1
    v_and_b32 v160, 1, v160
    v_add_u32 v160, -1, v160
    v_and_b32 v12, 0x3f803f80, v160
    v_mov_b32 v13, v12
    v_mov_b32 v14, v12
    v_mov_b32 v15, v12
    s_waitcnt lgkmcnt(0)
    s_mov_b32 s8, s4
    s_and_b32 s9, s5, 0xffff
    s_mov_b32 s10, 2621440
    s_mov_b32 s11, 0x20000
    s_mov_b32 s12, s6
    s_and_b32 s13, s7, 0xffff
    s_mov_b32 s14, 2457600
    s_mov_b32 s15, 0x20000
    s_mov_b32 s16, s44
    s_and_b32 s17, s45, 0xffff
    s_mov_b32 s18, 27262976
    s_mov_b32 s19, 0x20000
    s_mul_i32 s34, s2, 384
    s_add_u32 s34, s34, 26214400
    v_lshrrev_b32 v160, 3, v29
    s_mov_b64 exec, 0xffffff
    buffer_store_dwordx4 v[96:99], v160, s[16:19], s34 offen
    s_mov_b64 exec, -1
    s_mul_i32 s25, s24, 13
    s_lshr_b32 s25, s25, 6
    s_mul_i32 s34, s25, 5
    s_sub_u32 s26, s24, s34
    s_lshl_b32 s34, s23, 2
    s_lshl_b32 s35, s21, 1
    s_add_u32 s39, s34, s35
    s_add_u32 s40, s39, 1
    s_cmp_eq_u32 s25, 0
    s_mov_b32 s37, 163840
    s_cmov_b32 s37, 81920
    s_mov_b32 s38, 2560
    s_cmov_b32 s38, 1280
    s_cselect_b32 s36, 5242880, 0
    s_cselect_b32 s41, 0x3ea52b5c, 1.0
    s_mul_i32 s39, s39, s38
    s_mul_i32 s40, s40, s38
    s_add_u32 s39, s39, s36
    s_add_u32 s40, s40, s36
    s_lshl_b32 s34, s26, 7
    s_lshl_b32 s35, s22, 6
    s_add_u32 s34, s34, s35
    s_lshl_b32 s35, s21, 5
    s_add_u32 s34, s34, s35
    s_xor_b32 s35, s34, 32
    s_mov_b32 s27, 0
    s_cmp_eq_u32 s25, 2
    s_cbranch_scc1 L_k1_vpath
    s_lshr_b32 s36, s34, 3
    v_add_u32 v160, s36, v9
    v_mul_u32_u24 v161, 13108, v160
    v_lshrrev_b32 v161, 16, v161
    v_mul_u32_u24 v162, 5, v161
    v_sub_u32 v162, v160, v162
    v_cmp_lt_u32 vcc, 2, v162
    v_lshlrev_b32 v161, 1, v161
    v_subrev_u32 v163, 3, v162
    v_cndmask_b32 v163, v162, v163, vcc
    v_cndmask_b32 v166, 0, 1, vcc
    v_add_u32 v161, v161, v166
    v_cmp_eq_u32 s[60:61], 2, v162
    v_lshlrev_b32 v163, 9, v163
    v_lshlrev_b32 v166, 4, v8
    v_lshlrev_b32 v167, 3, v8
    v_cndmask_b32 v166, v166, v167, s[60:61]
    v_add_u32 v163, v163, v166
    v_mad_u32_u24 v20, v161, s37, v163
    v_add_u32 v24, s37, v20
    v_add_u32 v160, s36, v9
    v_add_u32 v160, 2, v160
    v_mul_u32_u24 v161, 13108, v160
    v_lshrrev_b32 v161, 16, v161
    v_mul_u32_u24 v162, 5, v161
    v_sub_u32 v162, v160, v162
    v_cmp_lt_u32 vcc, 2, v162
    v_lshlrev_b32 v161, 1, v161
    v_subrev_u32 v163, 3, v162
    v_cndmask_b32 v163, v162, v163, vcc
    v_cndmask_b32 v166, 0, 1, vcc
    v_add_u32 v161, v161, v166
    v_cmp_eq_u32 s[62:63], 2, v162
    v_lshlrev_b32 v163, 9, v163
    v_lshlrev_b32 v166, 4, v8
    v_lshlrev_b32 v167, 3, v8
    v_cndmask_b32 v166, v166, v167, s[62:63]
    v_add_u32 v163, v163, v166
    v_mad_u32_u24 v21, v161, s37, v163
    v_add_u32 v25, s37, v21
    s_lshr_b32 s36, s35, 3
    v_add_u32 v160, s36, v9
    v_mul_u32_u24 v161, 13108, v160
    v_lshrrev_b32 v161, 16, v161
    v_mul_u32_u24 v162, 5, v161
    v_sub_u32 v162, v160, v162
    v_cmp_lt_u32 vcc, 2, v162
    v_lshlrev_b32 v161, 1, v161
    v_subrev_u32 v163, 3, v162
    v_cndmask_b32 v163, v162, v163, vcc
    v_cndmask_b32 v166, 0, 1, vcc
    v_add_u32 v161, v161, v166
    v_cmp_eq_u32 s[64:65], 2, v162
    v_lshlrev_b32 v163, 9, v163
    v_lshlrev_b32 v166, 4, v8
    v_lshlrev_b32 v167, 3, v8
    v_cndmask_b32 v166, v166, v167, s[64:65]
    v_add_u32 v163, v163, v166
    v_mad_u32_u24 v22, v161, s37, v163
    v_add_u32 v26, s37, v22
    v_add_u32 v160, s36, v9
    v_add_u32 v160, 2, v160
    v_mul_u32_u24 v161, 13108, v160
    v_lshrrev_b32 v161, 16, v161
    v_mul_u32_u24 v162, 5, v161
    v_sub_u32 v162, v160, v162
    v_cmp_lt_u32 vcc, 2, v162
    v_lshlrev_b32 v161, 1, v161
    v_subrev_u32 v163, 3, v162
    v_cndmask_b32 v163, v162, v163, vcc
    v_cndmask_b32 v166, 0, 1, vcc
    v_add_u32 v161, v161, v166
    v_cmp_eq_u32 s[66:67], 2, v162
    v_lshlrev_b32 v163, 9, v163
    v_lshlrev_b32 v166, 4, v8
    v_lshlrev_b32 v167, 3, v8
    v_cndmask_b32 v166, v166, v167, s[66:67]
    v_add_u32 v163, v163, v166
    v_mad_u32_u24 v23, v161, s37, v163
    v_add_u32 v27, s37, v23
    s_barrier
    ds_read_b128 v[32:35], v2
    ds_read_b64_tr_b16 v[40:41], v6 offset:0
    ds_read_b64_tr_b16 v[42:43], v6 offset:1024
    ds_read_b128 v[36:39], v2 offset:4096
    ds_read_b64_tr_b16 v[44:45], v7 offset:0
    ds_read_b64_tr_b16 v[46:47], v7 offset:1024
    ds_read_b128 v[48:51], v3
    ds_read_b64_tr_b16 v[56:57], v6 offset:4096
    ds_read_b64_tr_b16 v[58:59], v6 offset:5120
    ds_read_b128 v[52:55], v3 offset:4096
    ds_read_b64_tr_b16 v[60:61], v7 offset:4096
    ds_read_b64_tr_b16 v[62:63], v7 offset:5120
.p2align 3
L_k1_loop_qk:
    s_waitcnt lgkmcnt(6)
    v_mfma_f32_32x32x16_bf16 v[96:111], v[40:43], v[32:35], v[96:111]
    ds_read_b128 v[64:67], v4
    ds_read_b64_tr_b16 v[72:73], v6 offset:8192
    v_mfma_f32_32x32x16_bf16 v[112:127], v[40:43], v[36:39], v[112:127]
    ds_read_b64_tr_b16 v[74:75], v6 offset:9216
    ds_read_b128 v[68:71], v4 offset:4096
    v_mfma_f32_16x16x32_bf16 v[16:19], v[40:43], v[12:15], v[16:19]
    v_mfma_f32_32x32x16_bf16 v[128:143], v[44:47], v[32:35], v[128:143]
    ds_read_b64_tr_b16 v[76:77], v7 offset:8192
    ds_read_b64_tr_b16 v[78:79], v7 offset:9216
    v_mfma_f32_32x32x16_bf16 v[144:159], v[44:47], v[36:39], v[144:159]
    s_cmp_eq_u32 s27, 4
    s_mov_b32 s31, 32768
    s_cmov_b32 s31, 4294836224
    v_add_u32 v2, s31, v2
    v_add_u32 v3, s31, v3
    v_add_u32 v4, s31, v4
    s_waitcnt lgkmcnt(6)
    v_mfma_f32_32x32x16_bf16 v[96:111], v[56:59], v[48:51], v[96:111]
    ds_read_b128 v[80:83], v5
    ds_read_b64_tr_b16 v[88:89], v6 offset:12288
    v_mfma_f32_32x32x16_bf16 v[112:127], v[56:59], v[52:55], v[112:127]
    ds_read_b64_tr_b16 v[90:91], v6 offset:13312
    ds_read_b128 v[84:87], v5 offset:4096
    v_mfma_f32_16x16x32_bf16 v[16:19], v[56:59], v[12:15], v[16:19]
    v_mfma_f32_32x32x16_bf16 v[128:143], v[60:63], v[48:51], v[128:143]
    ds_read_b64_tr_b16 v[92:93], v7 offset:12288
    ds_read_b64_tr_b16 v[94:95], v7 offset:13312
    v_mfma_f32_32x32x16_bf16 v[144:159], v[60:63], v[52:55], v[144:159]
    v_add_u32 v6, s31, v6
    v_add_u32 v7, s31, v7
    v_add_u32 v5, s31, v5
    s_barrier
    s_waitcnt lgkmcnt(6)
    v_mfma_f32_32x32x16_bf16 v[96:111], v[72:75], v[64:67], v[96:111]
    ds_read_b128 v[32:35], v2
    ds_read_b64_tr_b16 v[40:41], v6 offset:0
    v_mfma_f32_32x32x16_bf16 v[112:127], v[72:75], v[68:71], v[112:127]
    ds_read_b64_tr_b16 v[42:43], v6 offset:1024
    ds_read_b128 v[36:39], v2 offset:4096
    v_mfma_f32_16x16x32_bf16 v[16:19], v[72:75], v[12:15], v[16:19]
    v_mfma_f32_32x32x16_bf16 v[128:143], v[76:79], v[64:67], v[128:143]
    ds_read_b64_tr_b16 v[44:45], v7 offset:0
    ds_read_b64_tr_b16 v[46:47], v7 offset:1024
    v_mfma_f32_32x32x16_bf16 v[144:159], v[76:79], v[68:71], v[144:159]
    s_waitcnt lgkmcnt(6)
    v_mfma_f32_32x32x16_bf16 v[96:111], v[88:91], v[80:83], v[96:111]
    ds_read_b128 v[48:51], v3
    ds_read_b64_tr_b16 v[56:57], v6 offset:4096
    v_mfma_f32_32x32x16_bf16 v[112:127], v[88:91], v[84:87], v[112:127]
    ds_read_b64_tr_b16 v[58:59], v6 offset:5120
    ds_read_b128 v[52:55], v3 offset:4096
    v_mfma_f32_16x16x32_bf16 v[16:19], v[88:91], v[12:15], v[16:19]
    v_mfma_f32_32x32x16_bf16 v[128:143], v[92:95], v[80:83], v[128:143]
    ds_read_b64_tr_b16 v[60:61], v7 offset:4096
    ds_read_b64_tr_b16 v[62:63], v7 offset:5120
    v_mfma_f32_32x32x16_bf16 v[144:159], v[92:95], v[84:87], v[144:159]
    s_add_u32 s27, s27, 1
    s_cmp_lt_u32 s27, 10
    s_cbranch_scc1 L_k1_loop_qk
    s_lshl_b32 s36, s22, 8
    s_lshl_b32 s31, s21, 7
    s_add_u32 s36, s36, s31
    s_add_u32 s36, s36, 65536
    v_and_b32 v161, 1, v1
    v_lshl_add_u32 v161, v161, 6, s36
    v_and_b32 v162, 48, v1
    v_add_u32 v161, v161, v162
    ds_write_b128 v161, v[16:19] offset:1024
    s_lshl_b32 s31, s21, 8
    s_add_u32 s31, s31, 65536
    s_waitcnt lgkmcnt(0)
    s_barrier
    v_lshl_add_u32 v164, v8, 2, s31
    ds_read_b32 v160, v164
    ds_read_b32 v162, v164 offset:512
    ds_read_b32 v161, v164 offset:128
    ds_read_b32 v163, v164 offset:640
    v_lshl_add_u32 v166, v9, 4, s36
    v_xor_b32 v167, 128, v166
    ds_read_b128 v[32:35], v166 offset:1024
    ds_read_b128 v[36:39], v166 offset:1056
    ds_read_b128 v[40:43], v166 offset:1088
    ds_read_b128 v[44:47], v166 offset:1120
    ds_read_b128 v[48:51], v167 offset:1024
    ds_read_b128 v[52:55], v167 offset:1056
    ds_read_b128 v[56:59], v167 offset:1088
    ds_read_b128 v[60:63], v167 offset:1120
    s_waitcnt lgkmcnt(8)
    v_mul_f32 v162, s41, v162
    v_mul_f32 v163, s41, v163
    s_waitcnt lgkmcnt(4)
    v_pk_fma_f32 v[96:97], v[32:33], v[160:161], v[96:97] op_sel:[0,0,0] op_sel_hi:[1,0,1] neg_lo:[0,1,0] neg_hi:[0,1,0]
    v_pk_fma_f32 v[98:99], v[34:35], v[160:161], v[98:99] op_sel:[0,0,0] op_sel_hi:[1,0,1] neg_lo:[0,1,0] neg_hi:[0,1,0]
    v_pk_mul_f32 v[96:97], v[96:97], v[162:163] op_sel:[0,0] op_sel_hi:[1,0]
    v_pk_mul_f32 v[98:99], v[98:99], v[162:163] op_sel:[0,0] op_sel_hi:[1,0]
    v_cvt_pk_bf16_f32 v64, v96, v97
    v_cvt_pk_bf16_f32 v65, v98, v99
    v_pk_fma_f32 v[100:101], v[36:37], v[160:161], v[100:101] op_sel:[0,0,0] op_sel_hi:[1,0,1] neg_lo:[0,1,0] neg_hi:[0,1,0]
    v_pk_fma_f32 v[102:103], v[38:39], v[160:161], v[102:103] op_sel:[0,0,0] op_sel_hi:[1,0,1] neg_lo:[0,1,0] neg_hi:[0,1,0]
    v_pk_mul_f32 v[100:101], v[100:101], v[162:163] op_sel:[0,0] op_sel_hi:[1,0]
    v_pk_mul_f32 v[102:103], v[102:103], v[162:163] op_sel:[0,0] op_sel_hi:[1,0]
    v_cvt_pk_bf16_f32 v66, v100, v101
    v_cvt_pk_bf16_f32 v67, v102, v103
    s_nop 1
    v_permlane32_swap_b32 v64, v66
    v_permlane32_swap_b32 v65, v67
    s_not_b64 exec, s[60:61]
    buffer_store_dwordx4 v[64:67], v20, s[16:19], s39 offen sc0 sc1
    s_mov_b64 exec, s[60:61]
    s_cbranch_execz L_k1sp_11
    buffer_store_dwordx2 v[64:65], v20, s[16:19], s39 offen sc0 sc1
    buffer_store_dwordx2 v[66:67], v24, s[16:19], s39 offen sc0 sc1
L_k1sp_11:
    s_mov_b64 exec, -1
    v_pk_fma_f32 v[104:105], v[40:41], v[160:161], v[104:105] op_sel:[0,0,0] op_sel_hi:[1,0,1] neg_lo:[0,1,0] neg_hi:[0,1,0]
    v_pk_fma_f32 v[106:107], v[42:43], v[160:161], v[106:107] op_sel:[0,0,0] op_sel_hi:[1,0,1] neg_lo:[0,1,0] neg_hi:[0,1,0]
    v_pk_mul_f32 v[104:105], v[104:105], v[162:163] op_sel:[0,0] op_sel_hi:[1,0]
    v_pk_mul_f32 v[106:107], v[106:107], v[162:163] op_sel:[0,0] op_sel_hi:[1,0]
    v_cvt_pk_bf16_f32 v68, v104, v105
    v_cvt_pk_bf16_f32 v69, v106, v107
    v_pk_fma_f32 v[108:109], v[44:45], v[160:161], v[108:109] op_sel:[0,0,0] op_sel_hi:[1,0,1] neg_lo:[0,1,0] neg_hi:[0,1,0]
    v_pk_fma_f32 v[110:111], v[46:47], v[160:161], v[110:111] op_sel:[0,0,0] op_sel_hi:[1,0,1] neg_lo:[0,1,0] neg_hi:[0,1,0]
    v_pk_mul_f32 v[108:109], v[108:109], v[162:163] op_sel:[0,0] op_sel_hi:[1,0]
    v_pk_mul_f32 v[110:111], v[110:111], v[162:163] op_sel:[0,0] op_sel_hi:[1,0]
    v_cvt_pk_bf16_f32 v70, v108, v109
    v_cvt_pk_bf16_f32 v71, v110, v111
    s_nop 1
    v_permlane32_swap_b32 v68, v70
    v_permlane32_swap_b32 v69, v71
    s_not_b64 exec, s[62:63]
    buffer_store_dwordx4 v[68:71], v21, s[16:19], s39 offen sc0 sc1
    s_mov_b64 exec, s[62:63]
    s_cbranch_execz L_k1sp_12
    buffer_store_dwordx2 v[68:69], v21, s[16:19], s39 offen sc0 sc1
    buffer_store_dwordx2 v[70:71], v25, s[16:19], s39 offen sc0 sc1
L_k1sp_12:
    s_mov_b64 exec, -1
    v_pk_fma_f32 v[112:113], v[32:33], v[160:161], v[112:113] op_sel:[0,1,0] op_sel_hi:[1,1,1] neg_lo:[0,1,0] neg_hi:[0,1,0]
    v_pk_fma_f32 v[114:115], v[34:35], v[160:161], v[114:115] op_sel:[0,1,0] op_sel_hi:[1,1,1] neg_lo:[0,1,0] neg_hi:[0,1,0]
    v_pk_mul_f32 v[112:113], v[112:113], v[162:163] op_sel:[0,1] op_sel_hi:[1,1]
    v_pk_mul_f32 v[114:115], v[114:115], v[162:163] op_sel:[0,1] op_sel_hi:[1,1]
    v_cvt_pk_bf16_f32 v72, v112, v113
    v_cvt_pk_bf16_f32 v73, v114, v115
    v_pk_fma_f32 v[116:117], v[36:37], v[160:161], v[116:117] op_sel:[0,1,0] op_sel_hi:[1,1,1] neg_lo:[0,1,0] neg_hi:[0,1,0]
    v_pk_fma_f32 v[118:119], v[38:39], v[160:161], v[118:119] op_sel:[0,1,0] op_sel_hi:[1,1,1] neg_lo:[0,1,0] neg_hi:[0,1,0]
    v_pk_mul_f32 v[116:117], v[116:117], v[162:163] op_sel:[0,1] op_sel_hi:[1,1]
    v_pk_mul_f32 v[118:119], v[118:119], v[162:163] op_sel:[0,1] op_sel_hi:[1,1]
    v_cvt_pk_bf16_f32 v74, v116, v117
    v_cvt_pk_bf16_f32 v75, v118, v119
    s_nop 1
    v_permlane32_swap_b32 v72, v74
    v_permlane32_swap_b32 v73, v75
    s_not_b64 exec, s[60:61]
    buffer_store_dwordx4 v[72:75], v20, s[16:19], s40 offen sc0 sc1
    s_mov_b64 exec, s[60:61]
    s_cbranch_execz L_k1sp_13
    buffer_store_dwordx2 v[72:73], v20, s[16:19], s40 offen sc0 sc1
    buffer_store_dwordx2 v[74:75], v24, s[16:19], s40 offen sc0 sc1
L_k1sp_13:
    s_mov_b64 exec, -1
    v_pk_fma_f32 v[120:121], v[40:41], v[160:161], v[120:121] op_sel:[0,1,0] op_sel_hi:[1,1,1] neg_lo:[0,1,0] neg_hi:[0,1,0]
    v_pk_fma_f32 v[122:123], v[42:43], v[160:161], v[122:123] op_sel:[0,1,0] op_sel_hi:[1,1,1] neg_lo:[0,1,0] neg_hi:[0,1,0]
    v_pk_mul_f32 v[120:121], v[120:121], v[162:163] op_sel:[0,1] op_sel_hi:[1,1]
    v_pk_mul_f32 v[122:123], v[122:123], v[162:163] op_sel:[0,1] op_sel_hi:[1,1]
    v_cvt_pk_bf16_f32 v76, v120, v121
    v_cvt_pk_bf16_f32 v77, v122, v123
    v_pk_fma_f32 v[124:125], v[44:45], v[160:161], v[124:125] op_sel:[0,1,0] op_sel_hi:[1,1,1] neg_lo:[0,1,0] neg_hi:[0,1,0]
    v_pk_fma_f32 v[126:127], v[46:47], v[160:161], v[126:127] op_sel:[0,1,0] op_sel_hi:[1,1,1] neg_lo:[0,1,0] neg_hi:[0,1,0]
    v_pk_mul_f32 v[124:125], v[124:125], v[162:163] op_sel:[0,1] op_sel_hi:[1,1]
    v_pk_mul_f32 v[126:127], v[126:127], v[162:163] op_sel:[0,1] op_sel_hi:[1,1]
    v_cvt_pk_bf16_f32 v78, v124, v125
    v_cvt_pk_bf16_f32 v79, v126, v127
    s_nop 1
    v_permlane32_swap_b32 v76, v78
    v_permlane32_swap_b32 v77, v79
    s_not_b64 exec, s[62:63]
    buffer_store_dwordx4 v[76:79], v21, s[16:19], s40 offen sc0 sc1
    s_mov_b64 exec, s[62:63]
    s_cbranch_execz L_k1sp_14
    buffer_store_dwordx2 v[76:77], v21, s[16:19], s40 offen sc0 sc1
    buffer_store_dwordx2 v[78:79], v25, s[16:19], s40 offen sc0 sc1
L_k1sp_14:
    s_mov_b64 exec, -1
    s_waitcnt lgkmcnt(0)
    v_pk_fma_f32 v[128:129], v[48:49], v[160:161], v[128:129] op_sel:[0,0,0] op_sel_hi:[1,0,1] neg_lo:[0,1,0] neg_hi:[0,1,0]
    v_pk_fma_f32 v[130:131], v[50:51], v[160:161], v[130:131] op_sel:[0,0,0] op_sel_hi:[1,0,1] neg_lo:[0,1,0] neg_hi:[0,1,0]
    v_pk_mul_f32 v[128:129], v[128:129], v[162:163] op_sel:[0,0] op_sel_hi:[1,0]
    v_pk_mul_f32 v[130:131], v[130:131], v[162:163] op_sel:[0,0] op_sel_hi:[1,0]
    v_cvt_pk_bf16_f32 v80, v128, v129
    v_cvt_pk_bf16_f32 v81, v130, v131
    v_pk_fma_f32 v[132:133], v[52:53], v[160:161], v[132:133] op_sel:[0,0,0] op_sel_hi:[1,0,1] neg_lo:[0,1,0] neg_hi:[0,1,0]
    v_pk_fma_f32 v[134:135], v[54:55], v[160:161], v[134:135] op_sel:[0,0,0] op_sel_hi:[1,0,1] neg_lo:[0,1,0] neg_hi:[0,1,0]
    v_pk_mul_f32 v[132:133], v[132:133], v[162:163] op_sel:[0,0] op_sel_hi:[1,0]
    v_pk_mul_f32 v[134:135], v[134:135], v[162:163] op_sel:[0,0] op_sel_hi:[1,0]
    v_cvt_pk_bf16_f32 v82, v132, v133
    v_cvt_pk_bf16_f32 v83, v134, v135
    s_nop 1
    v_permlane32_swap_b32 v80, v82
    v_permlane32_swap_b32 v81, v83
    s_not_b64 exec, s[64:65]
    buffer_store_dwordx4 v[80:83], v22, s[16:19], s39 offen sc0 sc1
    s_mov_b64 exec, s[64:65]
    s_cbranch_execz L_k1sp_15
    buffer_store_dwordx2 v[80:81], v22, s[16:19], s39 offen sc0 sc1
    buffer_store_dwordx2 v[82:83], v26, s[16:19], s39 offen sc0 sc1
L_k1sp_15:
    s_mov_b64 exec, -1
    v_pk_fma_f32 v[136:137], v[56:57], v[160:161], v[136:137] op_sel:[0,0,0] op_sel_hi:[1,0,1] neg_lo:[0,1,0] neg_hi:[0,1,0]
    v_pk_fma_f32 v[138:139], v[58:59], v[160:161], v[138:139] op_sel:[0,0,0] op_sel_hi:[1,0,1] neg_lo:[0,1,0] neg_hi:[0,1,0]
    v_pk_mul_f32 v[136:137], v[136:137], v[162:163] op_sel:[0,0] op_sel_hi:[1,0]
    v_pk_mul_f32 v[138:139], v[138:139], v[162:163] op_sel:[0,0] op_sel_hi:[1,0]
    v_cvt_pk_bf16_f32 v84, v136, v137
    v_cvt_pk_bf16_f32 v85, v138, v139
    v_pk_fma_f32 v[140:141], v[60:61], v[160:161], v[140:141] op_sel:[0,0,0] op_sel_hi:[1,0,1] neg_lo:[0,1,0] neg_hi:[0,1,0]
    v_pk_fma_f32 v[142:143], v[62:63], v[160:161], v[142:143] op_sel:[0,0,0] op_sel_hi:[1,0,1] neg_lo:[0,1,0] neg_hi:[0,1,0]
    v_pk_mul_f32 v[140:141], v[140:141], v[162:163] op_sel:[0,0] op_sel_hi:[1,0]
    v_pk_mul_f32 v[142:143], v[142:143], v[162:163] op_sel:[0,0] op_sel_hi:[1,0]
    v_cvt_pk_bf16_f32 v86, v140, v141
    v_cvt_pk_bf16_f32 v87, v142, v143
    s_nop 1
    v_permlane32_swap_b32 v84, v86
    v_permlane32_swap_b32 v85, v87
    s_not_b64 exec, s[66:67]
    buffer_store_dwordx4 v[84:87], v23, s[16:19], s39 offen sc0 sc1
    s_mov_b64 exec, s[66:67]
    s_cbranch_execz L_k1sp_16
    buffer_store_dwordx2 v[84:85], v23, s[16:19], s39 offen sc0 sc1
    buffer_store_dwordx2 v[86:87], v27, s[16:19], s39 offen sc0 sc1
L_k1sp_16:
    s_mov_b64 exec, -1
    v_pk_fma_f32 v[144:145], v[48:49], v[160:161], v[144:145] op_sel:[0,1,0] op_sel_hi:[1,1,1] neg_lo:[0,1,0] neg_hi:[0,1,0]
    v_pk_fma_f32 v[146:147], v[50:51], v[160:161], v[146:147] op_sel:[0,1,0] op_sel_hi:[1,1,1] neg_lo:[0,1,0] neg_hi:[0,1,0]
    v_pk_mul_f32 v[144:145], v[144:145], v[162:163] op_sel:[0,1] op_sel_hi:[1,1]
    v_pk_mul_f32 v[146:147], v[146:147], v[162:163] op_sel:[0,1] op_sel_hi:[1,1]
    v_cvt_pk_bf16_f32 v88, v144, v145
    v_cvt_pk_bf16_f32 v89, v146, v147
    v_pk_fma_f32 v[148:149], v[52:53], v[160:161], v[148:149] op_sel:[0,1,0] op_sel_hi:[1,1,1] neg_lo:[0,1,0] neg_hi:[0,1,0]
    v_pk_fma_f32 v[150:151], v[54:55], v[160:161], v[150:151] op_sel:[0,1,0] op_sel_hi:[1,1,1] neg_lo:[0,1,0] neg_hi:[0,1,0]
    v_pk_mul_f32 v[148:149], v[148:149], v[162:163] op_sel:[0,1] op_sel_hi:[1,1]
    v_pk_mul_f32 v[150:151], v[150:151], v[162:163] op_sel:[0,1] op_sel_hi:[1,1]
    v_cvt_pk_bf16_f32 v90, v148, v149
    v_cvt_pk_bf16_f32 v91, v150, v151
    s_nop 1
    v_permlane32_swap_b32 v88, v90
    v_permlane32_swap_b32 v89, v91
    s_not_b64 exec, s[64:65]
    buffer_store_dwordx4 v[88:91], v22, s[16:19], s40 offen sc0 sc1
    s_mov_b64 exec, s[64:65]
    s_cbranch_execz L_k1sp_17
    buffer_store_dwordx2 v[88:89], v22, s[16:19], s40 offen sc0 sc1
    buffer_store_dwordx2 v[90:91], v26, s[16:19], s40 offen sc0 sc1
L_k1sp_17:
    s_mov_b64 exec, -1
    v_pk_fma_f32 v[152:153], v[56:57], v[160:161], v[152:153] op_sel:[0,1,0] op_sel_hi:[1,1,1] neg_lo:[0,1,0] neg_hi:[0,1,0]
    v_pk_fma_f32 v[154:155], v[58:59], v[160:161], v[154:155] op_sel:[0,1,0] op_sel_hi:[1,1,1] neg_lo:[0,1,0] neg_hi:[0,1,0]
    v_pk_mul_f32 v[152:153], v[152:153], v[162:163] op_sel:[0,1] op_sel_hi:[1,1]
    v_pk_mul_f32 v[154:155], v[154:155], v[162:163] op_sel:[0,1] op_sel_hi:[1,1]
    v_cvt_pk_bf16_f32 v92, v152, v153
    v_cvt_pk_bf16_f32 v93, v154, v155
    v_pk_fma_f32 v[156:157], v[60:61], v[160:161], v[156:157] op_sel:[0,1,0] op_sel_hi:[1,1,1] neg_lo:[0,1,0] neg_hi:[0,1,0]
    v_pk_fma_f32 v[158:159], v[62:63], v[160:161], v[158:159] op_sel:[0,1,0] op_sel_hi:[1,1,1] neg_lo:[0,1,0] neg_hi:[0,1,0]
    v_pk_mul_f32 v[156:157], v[156:157], v[162:163] op_sel:[0,1] op_sel_hi:[1,1]
    v_pk_mul_f32 v[158:159], v[158:159], v[162:163] op_sel:[0,1] op_sel_hi:[1,1]
    v_cvt_pk_bf16_f32 v94, v156, v157
    v_cvt_pk_bf16_f32 v95, v158, v159
    s_nop 1
    v_permlane32_swap_b32 v92, v94
    v_permlane32_swap_b32 v93, v95
    s_not_b64 exec, s[66:67]
    buffer_store_dwordx4 v[92:95], v23, s[16:19], s40 offen sc0 sc1
    s_mov_b64 exec, s[66:67]
    s_cbranch_execz L_k1sp_18
    buffer_store_dwordx2 v[92:93], v23, s[16:19], s40 offen sc0 sc1
    buffer_store_dwordx2 v[94:95], v27, s[16:19], s40 offen sc0 sc1
L_k1sp_18:
    s_mov_b64 exec, -1
    s_branch L_k1_fin
L_k1_vpath:
    v_add_u32 v160, s34, v8
    v_mul_u32_u24 v161, 3277, v160
    v_lshrrev_b32 v161, 16, v161
    v_mul_u32_u24 v162, 20, v161
    v_sub_u32 v162, v160, v162
    v_lshlrev_b32 v163, 4, v9
    v_lshl_add_u32 v163, v162, 5, v163
    v_add_u32 v163, 1280, v163
    v_mad_u32_u24 v20, v161, s37, v163
    v_add_u32 v160, s35, v8
    v_mul_u32_u24 v161, 3277, v160
    v_lshrrev_b32 v161, 16, v161
    v_mul_u32_u24 v162, 20, v161
    v_sub_u32 v162, v160, v162
    v_lshlrev_b32 v163, 4, v9
    v_lshl_add_u32 v163, v162, 5, v163
    v_add_u32 v163, 1280, v163
    v_mad_u32_u24 v21, v161, s37, v163
    s_barrier
    ds_read_b128 v[32:35], v2
    ds_read_b64_tr_b16 v[40:41], v6 offset:0
    ds_read_b64_tr_b16 v[42:43], v6 offset:1024
    ds_read_b128 v[36:39], v2 offset:4096
    ds_read_b64_tr_b16 v[44:45], v7 offset:0
    ds_read_b64_tr_b16 v[46:47], v7 offset:1024
    ds_read_b128 v[48:51], v3
    ds_read_b64_tr_b16 v[56:57], v6 offset:4096
    ds_read_b64_tr_b16 v[58:59], v6 offset:5120
    ds_read_b128 v[52:55], v3 offset:4096
    ds_read_b64_tr_b16 v[60:61], v7 offset:4096
    ds_read_b64_tr_b16 v[62:63], v7 offset:5120
.p2align 3
L_k1_loop_v:
    s_waitcnt lgkmcnt(6)
    v_mfma_f32_32x32x16_bf16 v[96:111], v[32:35], v[40:43], v[96:111]
    ds_read_b128 v[64:67], v4
    ds_read_b64_tr_b16 v[72:73], v6 offset:8192
    v_mfma_f32_32x32x16_bf16 v[112:127], v[36:39], v[40:43], v[112:127]
    ds_read_b64_tr_b16 v[74:75], v6 offset:9216
    ds_read_b128 v[68:71], v4 offset:4096
    v_mfma_f32_16x16x32_bf16 v[16:19], v[40:43], v[12:15], v[16:19]
    v_mfma_f32_32x32x16_bf16 v[128:143], v[32:35], v[44:47], v[128:143]
    ds_read_b64_tr_b16 v[76:77], v7 offset:8192
    ds_read_b64_tr_b16 v[78:79], v7 offset:9216
    v_mfma_f32_32x32x16_bf16 v[144:159], v[36:39], v[44:47], v[144:159]
    s_cmp_eq_u32 s27, 4
    s_mov_b32 s31, 32768
    s_cmov_b32 s31, 4294836224
    v_add_u32 v2, s31, v2
    v_add_u32 v3, s31, v3
    v_add_u32 v4, s31, v4
    s_waitcnt lgkmcnt(6)
    v_mfma_f32_32x32x16_bf16 v[96:111], v[48:51], v[56:59], v[96:111]
    ds_read_b128 v[80:83], v5
    ds_read_b64_tr_b16 v[88:89], v6 offset:12288
    v_mfma_f32_32x32x16_bf16 v[112:127], v[52:55], v[56:59], v[112:127]
    ds_read_b64_tr_b16 v[90:91], v6 offset:13312
    ds_read_b128 v[84:87], v5 offset:4096
    v_mfma_f32_16x16x32_bf16 v[16:19], v[56:59], v[12:15], v[16:19]
    v_mfma_f32_32x32x16_bf16 v[128:143], v[48:51], v[60:63], v[128:143]
    ds_read_b64_tr_b16 v[92:93], v7 offset:12288
    ds_read_b64_tr_b16 v[94:95], v7 offset:13312
    v_mfma_f32_32x32x16_bf16 v[144:159], v[52:55], v[60:63], v[144:159]
    v_add_u32 v6, s31, v6
    v_add_u32 v7, s31, v7
    v_add_u32 v5, s31, v5
    s_barrier
    s_waitcnt lgkmcnt(6)
    v_mfma_f32_32x32x16_bf16 v[96:111], v[64:67], v[72:75], v[96:111]
    ds_read_b128 v[32:35], v2
    ds_read_b64_tr_b16 v[40:41], v6 offset:0
    v_mfma_f32_32x32x16_bf16 v[112:127], v[68:71], v[72:75], v[112:127]
    ds_read_b64_tr_b16 v[42:43], v6 offset:1024
    ds_read_b128 v[36:39], v2 offset:4096
    v_mfma_f32_16x16x32_bf16 v[16:19], v[72:75], v[12:15], v[16:19]
    v_mfma_f32_32x32x16_bf16 v[128:143], v[64:67], v[76:79], v[128:143]
    ds_read_b64_tr_b16 v[44:45], v7 offset:0
    ds_read_b64_tr_b16 v[46:47], v7 offset:1024
    v_mfma_f32_32x32x16_bf16 v[144:159], v[68:71], v[76:79], v[144:159]
    s_waitcnt lgkmcnt(6)
    v_mfma_f32_32x32x16_bf16 v[96:111], v[80:83], v[88:91], v[96:111]
    ds_read_b128 v[48:51], v3
    ds_read_b64_tr_b16 v[56:57], v6 offset:4096
    v_mfma_f32_32x32x16_bf16 v[112:127], v[84:87], v[88:91], v[112:127]
    ds_read_b64_tr_b16 v[58:59], v6 offset:5120
    ds_read_b128 v[52:55], v3 offset:4096
    v_mfma_f32_16x16x32_bf16 v[16:19], v[88:91], v[12:15], v[16:19]
    v_mfma_f32_32x32x16_bf16 v[128:143], v[80:83], v[92:95], v[128:143]
    ds_read_b64_tr_b16 v[60:61], v7 offset:4096
    ds_read_b64_tr_b16 v[62:63], v7 offset:5120
    v_mfma_f32_32x32x16_bf16 v[144:159], v[84:87], v[92:95], v[144:159]
    s_add_u32 s27, s27, 1
    s_cmp_lt_u32 s27, 10
    s_cbranch_scc1 L_k1_loop_v
    s_lshl_b32 s36, s22, 8
    s_lshl_b32 s31, s21, 7
    s_add_u32 s36, s36, s31
    s_add_u32 s36, s36, 65536
    v_and_b32 v161, 1, v1
    v_lshl_add_u32 v161, v161, 6, s36
    v_and_b32 v162, 48, v1
    v_add_u32 v161, v161, v162
    ds_write_b128 v161, v[16:19] offset:1024
    s_lshl_b32 s31, s21, 8
    s_add_u32 s31, s31, 65536
    s_waitcnt lgkmcnt(0)
    s_barrier
    v_lshl_add_u32 v164, v8, 2, s36
    v_xor_b32 v165, 128, v164
    ds_read_b32 v160, v164 offset:1024
    ds_read_b32 v161, v165 offset:1024
    v_lshl_add_u32 v166, v9, 4, s31
    ds_read_b128 v[32:35], v166 offset:0
    ds_read_b128 v[64:67], v166 offset:512
    ds_read_b128 v[36:39], v166 offset:32
    ds_read_b128 v[68:71], v166 offset:544
    ds_read_b128 v[40:43], v166 offset:64
    ds_read_b128 v[72:75], v166 offset:576
    ds_read_b128 v[44:47], v166 offset:96
    ds_read_b128 v[76:79], v166 offset:608
    s_waitcnt lgkmcnt(0)
    ds_read_b128 v[48:51], v166 offset:128
    ds_read_b128 v[80:83], v166 offset:640
    ds_read_b128 v[52:55], v166 offset:160
    ds_read_b128 v[84:87], v166 offset:672
    ds_read_b128 v[56:59], v166 offset:192
    ds_read_b128 v[88:91], v166 offset:704
    ds_read_b128 v[60:63], v166 offset:224
    ds_read_b128 v[92:95], v166 offset:736
    v_pk_fma_f32 v[96:97], v[32:33], v[160:161], v[96:97] op_sel:[0,0,0] op_sel_hi:[1,0,1] neg_lo:[0,1,0] neg_hi:[0,1,0]
    v_pk_fma_f32 v[98:99], v[34:35], v[160:161], v[98:99] op_sel:[0,0,0] op_sel_hi:[1,0,1] neg_lo:[0,1,0] neg_hi:[0,1,0]
    v_pk_fma_f32 v[100:101], v[36:37], v[160:161], v[100:101] op_sel:[0,0,0] op_sel_hi:[1,0,1] neg_lo:[0,1,0] neg_hi:[0,1,0]
    v_pk_fma_f32 v[102:103], v[38:39], v[160:161], v[102:103] op_sel:[0,0,0] op_sel_hi:[1,0,1] neg_lo:[0,1,0] neg_hi:[0,1,0]
    v_pk_mul_f32 v[96:97], v[96:97], v[64:65]
    v_pk_mul_f32 v[98:99], v[98:99], v[66:67]
    v_pk_mul_f32 v[100:101], v[100:101], v[68:69]
    v_pk_mul_f32 v[102:103], v[102:103], v[70:71]
    v_cvt_pk_bf16_f32 v96, v96, v97
    v_cvt_pk_bf16_f32 v97, v98, v99
    v_cvt_pk_bf16_f32 v98, v100, v101
    v_cvt_pk_bf16_f32 v99, v102, v103
    buffer_store_dwordx4 v[96:99], v20, s[16:19], s39 offen offset:0 sc0 sc1
    v_pk_fma_f32 v[104:105], v[40:41], v[160:161], v[104:105] op_sel:[0,0,0] op_sel_hi:[1,0,1] neg_lo:[0,1,0] neg_hi:[0,1,0]
    v_pk_fma_f32 v[106:107], v[42:43], v[160:161], v[106:107] op_sel:[0,0,0] op_sel_hi:[1,0,1] neg_lo:[0,1,0] neg_hi:[0,1,0]
    v_pk_fma_f32 v[108:109], v[44:45], v[160:161], v[108:109] op_sel:[0,0,0] op_sel_hi:[1,0,1] neg_lo:[0,1,0] neg_hi:[0,1,0]
    v_pk_fma_f32 v[110:111], v[46:47], v[160:161], v[110:111] op_sel:[0,0,0] op_sel_hi:[1,0,1] neg_lo:[0,1,0] neg_hi:[0,1,0]
    v_pk_mul_f32 v[104:105], v[104:105], v[72:73]
    v_pk_mul_f32 v[106:107], v[106:107], v[74:75]
    v_pk_mul_f32 v[108:109], v[108:109], v[76:77]
    v_pk_mul_f32 v[110:111], v[110:111], v[78:79]
    v_cvt_pk_bf16_f32 v104, v104, v105
    v_cvt_pk_bf16_f32 v105, v106, v107
    v_cvt_pk_bf16_f32 v106, v108, v109
    v_cvt_pk_bf16_f32 v107, v110, v111
    buffer_store_dwordx4 v[104:107], v20, s[16:19], s39 offen offset:640 sc0 sc1
    v_pk_fma_f32 v[128:129], v[32:33], v[160:161], v[128:129] op_sel:[0,1,0] op_sel_hi:[1,1,1] neg_lo:[0,1,0] neg_hi:[0,1,0]
    v_pk_fma_f32 v[130:131], v[34:35], v[160:161], v[130:131] op_sel:[0,1,0] op_sel_hi:[1,1,1] neg_lo:[0,1,0] neg_hi:[0,1,0]
    v_pk_fma_f32 v[132:133], v[36:37], v[160:161], v[132:133] op_sel:[0,1,0] op_sel_hi:[1,1,1] neg_lo:[0,1,0] neg_hi:[0,1,0]
    v_pk_fma_f32 v[134:135], v[38:39], v[160:161], v[134:135] op_sel:[0,1,0] op_sel_hi:[1,1,1] neg_lo:[0,1,0] neg_hi:[0,1,0]
    v_pk_mul_f32 v[128:129], v[128:129], v[64:65]
    v_pk_mul_f32 v[130:131], v[130:131], v[66:67]
    v_pk_mul_f32 v[132:133], v[132:133], v[68:69]
    v_pk_mul_f32 v[134:135], v[134:135], v[70:71]
    v_cvt_pk_bf16_f32 v128, v128, v129
    v_cvt_pk_bf16_f32 v129, v130, v131
    v_cvt_pk_bf16_f32 v130, v132, v133
    v_cvt_pk_bf16_f32 v131, v134, v135
    buffer_store_dwordx4 v[128:131], v21, s[16:19], s39 offen offset:0 sc0 sc1
    v_pk_fma_f32 v[136:137], v[40:41], v[160:161], v[136:137] op_sel:[0,1,0] op_sel_hi:[1,1,1] neg_lo:[0,1,0] neg_hi:[0,1,0]
    v_pk_fma_f32 v[138:139], v[42:43], v[160:161], v[138:139] op_sel:[0,1,0] op_sel_hi:[1,1,1] neg_lo:[0,1,0] neg_hi:[0,1,0]
    v_pk_fma_f32 v[140:141], v[44:45], v[160:161], v[140:141] op_sel:[0,1,0] op_sel_hi:[1,1,1] neg_lo:[0,1,0] neg_hi:[0,1,0]
    v_pk_fma_f32 v[142:143], v[46:47], v[160:161], v[142:143] op_sel:[0,1,0] op_sel_hi:[1,1,1] neg_lo:[0,1,0] neg_hi:[0,1,0]
    v_pk_mul_f32 v[136:137], v[136:137], v[72:73]
    v_pk_mul_f32 v[138:139], v[138:139], v[74:75]
    v_pk_mul_f32 v[140:141], v[140:141], v[76:77]
    v_pk_mul_f32 v[142:143], v[142:143], v[78:79]
    v_cvt_pk_bf16_f32 v136, v136, v137
    v_cvt_pk_bf16_f32 v137, v138, v139
    v_cvt_pk_bf16_f32 v138, v140, v141
    v_cvt_pk_bf16_f32 v139, v142, v143
    buffer_store_dwordx4 v[136:139], v21, s[16:19], s39 offen offset:640 sc0 sc1
    s_waitcnt lgkmcnt(0)
    v_pk_fma_f32 v[112:113], v[48:49], v[160:161], v[112:113] op_sel:[0,0,0] op_sel_hi:[1,0,1] neg_lo:[0,1,0] neg_hi:[0,1,0]
    v_pk_fma_f32 v[114:115], v[50:51], v[160:161], v[114:115] op_sel:[0,0,0] op_sel_hi:[1,0,1] neg_lo:[0,1,0] neg_hi:[0,1,0]
    v_pk_fma_f32 v[116:117], v[52:53], v[160:161], v[116:117] op_sel:[0,0,0] op_sel_hi:[1,0,1] neg_lo:[0,1,0] neg_hi:[0,1,0]
    v_pk_fma_f32 v[118:119], v[54:55], v[160:161], v[118:119] op_sel:[0,0,0] op_sel_hi:[1,0,1] neg_lo:[0,1,0] neg_hi:[0,1,0]
    v_pk_mul_f32 v[112:113], v[112:113], v[80:81]
    v_pk_mul_f32 v[114:115], v[114:115], v[82:83]
    v_pk_mul_f32 v[116:117], v[116:117], v[84:85]
    v_pk_mul_f32 v[118:119], v[118:119], v[86:87]
    v_cvt_pk_bf16_f32 v112, v112, v113
    v_cvt_pk_bf16_f32 v113, v114, v115
    v_cvt_pk_bf16_f32 v114, v116, v117
    v_cvt_pk_bf16_f32 v115, v118, v119
    buffer_store_dwordx4 v[112:115], v20, s[16:19], s40 offen offset:0 sc0 sc1
    v_pk_fma_f32 v[120:121], v[56:57], v[160:161], v[120:121] op_sel:[0,0,0] op_sel_hi:[1,0,1] neg_lo:[0,1,0] neg_hi:[0,1,0]
    v_pk_fma_f32 v[122:123], v[58:59], v[160:161], v[122:123] op_sel:[0,0,0] op_sel_hi:[1,0,1] neg_lo:[0,1,0] neg_hi:[0,1,0]
    v_pk_fma_f32 v[124:125], v[60:61], v[160:161], v[124:125] op_sel:[0,0,0] op_sel_hi:[1,0,1] neg_lo:[0,1,0] neg_hi:[0,1,0]
    v_pk_fma_f32 v[126:127], v[62:63], v[160:161], v[126:127] op_sel:[0,0,0] op_sel_hi:[1,0,1] neg_lo:[0,1,0] neg_hi:[0,1,0]
    v_pk_mul_f32 v[120:121], v[120:121], v[88:89]
    v_pk_mul_f32 v[122:123], v[122:123], v[90:91]
    v_pk_mul_f32 v[124:125], v[124:125], v[92:93]
    v_pk_mul_f32 v[126:127], v[126:127], v[94:95]
    v_cvt_pk_bf16_f32 v120, v120, v121
    v_cvt_pk_bf16_f32 v121, v122, v123
    v_cvt_pk_bf16_f32 v122, v124, v125
    v_cvt_pk_bf16_f32 v123, v126, v127
    buffer_store_dwordx4 v[120:123], v20, s[16:19], s40 offen offset:640 sc0 sc1
    v_pk_fma_f32 v[144:145], v[48:49], v[160:161], v[144:145] op_sel:[0,1,0] op_sel_hi:[1,1,1] neg_lo:[0,1,0] neg_hi:[0,1,0]
    v_pk_fma_f32 v[146:147], v[50:51], v[160:161], v[146:147] op_sel:[0,1,0] op_sel_hi:[1,1,1] neg_lo:[0,1,0] neg_hi:[0,1,0]
    v_pk_fma_f32 v[148:149], v[52:53], v[160:161], v[148:149] op_sel:[0,1,0] op_sel_hi:[1,1,1] neg_lo:[0,1,0] neg_hi:[0,1,0]
    v_pk_fma_f32 v[150:151], v[54:55], v[160:161], v[150:151] op_sel:[0,1,0] op_sel_hi:[1,1,1] neg_lo:[0,1,0] neg_hi:[0,1,0]
    v_pk_mul_f32 v[144:145], v[144:145], v[80:81]
    v_pk_mul_f32 v[146:147], v[146:147], v[82:83]
    v_pk_mul_f32 v[148:149], v[148:149], v[84:85]
    v_pk_mul_f32 v[150:151], v[150:151], v[86:87]
    v_cvt_pk_bf16_f32 v144, v144, v145
    v_cvt_pk_bf16_f32 v145, v146, v147
    v_cvt_pk_bf16_f32 v146, v148, v149
    v_cvt_pk_bf16_f32 v147, v150, v151
    buffer_store_dwordx4 v[144:147], v21, s[16:19], s40 offen offset:0 sc0 sc1
    v_pk_fma_f32 v[152:153], v[56:57], v[160:161], v[152:153] op_sel:[0,1,0] op_sel_hi:[1,1,1] neg_lo:[0,1,0] neg_hi:[0,1,0]
    v_pk_fma_f32 v[154:155], v[58:59], v[160:161], v[154:155] op_sel:[0,1,0] op_sel_hi:[1,1,1] neg_lo:[0,1,0] neg_hi:[0,1,0]
    v_pk_fma_f32 v[156:157], v[60:61], v[160:161], v[156:157] op_sel:[0,1,0] op_sel_hi:[1,1,1] neg_lo:[0,1,0] neg_hi:[0,1,0]
    v_pk_fma_f32 v[158:159], v[62:63], v[160:161], v[158:159] op_sel:[0,1,0] op_sel_hi:[1,1,1] neg_lo:[0,1,0] neg_hi:[0,1,0]
    v_pk_mul_f32 v[152:153], v[152:153], v[88:89]
    v_pk_mul_f32 v[154:155], v[154:155], v[90:91]
    v_pk_mul_f32 v[156:157], v[156:157], v[92:93]
    v_pk_mul_f32 v[158:159], v[158:159], v[94:95]
    v_cvt_pk_bf16_f32 v152, v152, v153
    v_cvt_pk_bf16_f32 v153, v154, v155
    v_cvt_pk_bf16_f32 v154, v156, v157
    v_cvt_pk_bf16_f32 v155, v158, v159
    buffer_store_dwordx4 v[152:155], v21, s[16:19], s40 offen offset:640 sc0 sc1
L_k1_fin:
L_k1_end:
    s_endpgm
.section .rodata,"a"
.p2align 6
.amdhsa_kernel qkv_kernel
  .amdhsa_next_free_vgpr 168
  .amdhsa_next_free_sgpr 72
  .amdhsa_accum_offset 168
  .amdhsa_group_segment_fixed_size 0
  .amdhsa_kernarg_size 72
  .amdhsa_user_sgpr_count 2
  .amdhsa_user_sgpr_kernarg_segment_ptr 1
  .amdhsa_system_sgpr_workgroup_id_x 1
.end_amdhsa_kernel

.text
.globl fused_kernel
.p2align 8
.type fused_kernel,@function
fused_kernel:
    s_cmp_ge_u32 s2, 256
    s_cbranch_scc1 L_kf_end
    s_load_dwordx2 s[44:45], s[0:1], 64
    s_load_dwordx2 s[4:5], s[0:1], 16
    s_load_dwordx4 s[48:51], s[0:1], 32
    s_load_dwordx2 s[6:7], s[0:1], 0
    s_load_dwordx2 s[46:47], s[0:1], 48
    v_lshrrev_b32 v22, 6, v0
    v_and_b32 v1, 63, v0
    v_readfirstlane_b32 s24, v22
    s_and_b32 s52, s2, 7
    s_lshr_b32 s53, s2, 3
    s_lshl_b32 s25, s52, 2
    s_lshr_b32 s33, s53, 3
    s_add_u32 s25, s25, s33
    s_and_b32 s26, s53, 7
    s_lshl_b32 s26, s26, 3
    s_and_b32 s33, s24, 3
    s_lshl_b32 s33, s33, 1
    s_add_u32 s26, s26, s33
    s_bfe_u32 s35, s24, 0x10002
    s_add_u32 s26, s26, s35
    s_lshr_b32 s57, s53, 2
    s_lshr_b32 s59, s53, 1
    s_mov_b32 s60, 0
    s_mov_b32 s61, 0
    s_mov_b32 s62, 0
    v_and_b32 v2, 31, v1
    v_lshrrev_b32 v3, 5, v1
    s_cmp_lt_u32 s24, 8
    s_cbranch_scc1 L_kf_compute
    s_setprio 3
    s_mul_i32 s31, s25, 163840
    v_lshl_add_u32 v26, v1, 4, s31
    s_mov_b32 s38, 16384
    s_waitcnt lgkmcnt(0)
    s_mov_b32 s16, s44
    s_and_b32 s17, s45, 0xffff
    s_mov_b32 s18, 27262976
    s_mov_b32 s19, 0x20000
    s_mov_b32 s32, 1
L_kf_dma_a:
    s_mov_b32 m0, s38
    s_add_u32 s38, s38, 4096
    buffer_load_dwordx4 v26, s[16:19], m0 offen offset:0  lds
    buffer_load_dwordx4 v26, s[16:19], m0 offen offset:1024  lds
    buffer_load_dwordx4 v26, s[16:19], m0 offen offset:2048  lds
    buffer_load_dwordx4 v26, s[16:19], m0 offen offset:3072  lds
    s_add_u32 m0, m0, 81920
    s_sub_u32 s32, s32, 1
    buffer_load_dwordx4 v26, s[16:19], m0 offen offset:0  lds
    buffer_load_dwordx4 v26, s[16:19], m0 offen offset:1024  lds
    buffer_load_dwordx4 v26, s[16:19], m0 offen offset:2048  lds
    buffer_load_dwordx4 v26, s[16:19], m0 offen offset:3072  lds
    s_cmp_lg_u32 s32, 0
    s_cbranch_scc1 L_kf_dma_a
    s_barrier
    s_mov_b32 s32, 15
L_kf_dma_b:
    s_mov_b32 m0, s38
    s_add_u32 s38, s38, 4096
    buffer_load_dwordx4 v26, s[16:19], m0 offen offset:0  lds
    buffer_load_dwordx4 v26, s[16:19], m0 offen offset:1024  lds
    buffer_load_dwordx4 v26, s[16:19], m0 offen offset:2048  lds
    buffer_load_dwordx4 v26, s[16:19], m0 offen offset:3072  lds
    s_add_u32 m0, m0, 81920
    s_sub_u32 s32, s32, 1
    buffer_load_dwordx4 v26, s[16:19], m0 offen offset:0  lds
    buffer_load_dwordx4 v26, s[16:19], m0 offen offset:1024  lds
    buffer_load_dwordx4 v26, s[16:19], m0 offen offset:2048  lds
    buffer_load_dwordx4 v26, s[16:19], m0 offen offset:3072  lds
    s_cmp_lg_u32 s32, 0
    s_cbranch_scc1 L_kf_dma_b
    s_mov_b32 s8, s4
    s_and_b32 s9, s5, 0xffff
    s_mov_b32 s10, 819200
    s_mov_b32 s11, 0x20000
    s_mov_b32 s12, s48
    s_and_b32 s13, s49, 0xffff
    s_mov_b32 s14, 1966080
    s_mov_b32 s15, 0x20000
    s_mov_b32 s20, s50
    s_and_b32 s21, s51, 0xffff
    s_mov_b32 s22, 1966080
    s_mov_b32 s23, 0x20000
    v_and_b32 v27, 15, v1
    v_lshrrev_b32 v28, 2, v27
    v_mul_u32_u24 v28, 40, v28
    v_and_b32 v29, 3, v1
    v_lshl_add_u32 v4, v29, 1, v28
    v_bfe_u32 v27, v1, 4, 1
    v_mul_u32_u24 v27, 5120, v27
    v_add_u32 v27, v27, v4
    v_mul_u32_u24 v28, 25600, v3
    v_add_u32 v5, v27, v28
    v_mul_u32_u24 v28, 20480, v3
    v_add_u32 v7, v27, v28
    v_lshrrev_b32 v27, 4, v1
    v_mul_u32_u24 v27, 51200, v27
    v_add_u32 v6, v27, v4
    v_mul_u32_u24 v27, 24576, v3
    v_lshl_add_u32 v8, v2, 1, v27
    v_mul_u32_u24 v27, 122880, v3
    v_lshl_add_u32 v9, v2, 1, v27
    v_lshlrev_b32 v10, 4, v1
    v_mov_b32 v14, 0
    s_mov_b32 s40, 0xffff0000
    s_mov_b32 s41, 0x3f803f80
    s_waitcnt vmcnt(0)
    s_barrier
    s_lshl_b32 s42, s2, 2
    s_mul_i32 s31, s42, 10486
    s_lshr_b32 s31, s31, 20
    s_mul_i32 s34, s31, 100
    s_sub_u32 s32, s42, s34
    s_mul_i32 s33, s32, 209716
    s_lshr_b32 s33, s33, 20
    s_mul_i32 s34, s33, 5
    s_sub_u32 s38, s32, s34
    s_mul_i32 s31, s31, 160
    s_lshl_b32 s38, s38, 3
    s_add_u32 s38, s38, s31
    s_cmp_ge_u32 s33, 16
    s_cbranch_scc1 L_kfwo_19_b
    s_mul_i32 s33, s33, 51200
    s_add_u32 s38, s38, s33
    s_add_u32 s39, s38, 10240
    buffer_load_ushort v96, v5, s[8:11], s38 offen offset:0
    buffer_load_short_d16_hi v128, v5, s[8:11], s38 offen offset:1280
    buffer_load_ushort v97, v5, s[8:11], s38 offen offset:2560
    buffer_load_short_d16_hi v129, v5, s[8:11], s38 offen offset:3840
    buffer_load_ushort v98, v5, s[8:11], s39 offen offset:0
    buffer_load_short_d16_hi v130, v5, s[8:11], s39 offen offset:1280
    buffer_load_ushort v99, v5, s[8:11], s39 offen offset:2560
    buffer_load_short_d16_hi v131, v5, s[8:11], s39 offen offset:3840
    s_branch L_kfwo_19_d
L_kfwo_19_b:
    s_sub_u32 s33, s33, 16
    s_mul_i32 s33, s33, 204800
    s_add_u32 s38, s38, s33
    s_add_u32 s38, s38, 20480
    s_add_u32 s39, s38, 25600
    buffer_load_ushort v96, v6, s[8:11], s38 offen offset:0
    buffer_load_short_d16_hi v128, v6, s[8:11], s38 offen offset:1280
    buffer_load_ushort v97, v6, s[8:11], s38 offen offset:2560
    buffer_load_short_d16_hi v129, v6, s[8:11], s38 offen offset:3840
    buffer_load_ushort v98, v6, s[8:11], s39 offen offset:0
    buffer_load_short_d16_hi v130, v6, s[8:11], s39 offen offset:1280
    buffer_load_ushort v99, v6, s[8:11], s39 offen offset:2560
    buffer_load_short_d16_hi v131, v6, s[8:11], s39 offen offset:3840
L_kfwo_19_d:
    s_lshl_b32 s42, s2, 2
    s_add_u32 s42, s42, 1
    s_mul_i32 s31, s42, 10486
    s_lshr_b32 s31, s31, 20
    s_mul_i32 s34, s31, 100
    s_sub_u32 s32, s42, s34
    s_mul_i32 s33, s32, 209716
    s_lshr_b32 s33, s33, 20
    s_mul_i32 s34, s33, 5
    s_sub_u32 s38, s32, s34
    s_mul_i32 s31, s31, 160
    s_lshl_b32 s38, s38, 3
    s_add_u32 s38, s38, s31
    s_cmp_ge_u32 s33, 16
    s_cbranch_scc1 L_kfwo_20_b
    s_mul_i32 s33, s33, 51200
    s_add_u32 s38, s38, s33
    s_add_u32 s39, s38, 10240
    buffer_load_ushort v100, v5, s[8:11], s38 offen offset:0
    buffer_load_short_d16_hi v132, v5, s[8:11], s38 offen offset:1280
    buffer_load_ushort v101, v5, s[8:11], s38 offen offset:2560
    buffer_load_short_d16_hi v133, v5, s[8:11], s38 offen offset:3840
    buffer_load_ushort v102, v5, s[8:11], s39 offen offset:0
    buffer_load_short_d16_hi v134, v5, s[8:11], s39 offen offset:1280
    buffer_load_ushort v103, v5, s[8:11], s39 offen offset:2560
    buffer_load_short_d16_hi v135, v5, s[8:11], s39 offen offset:3840
    s_branch L_kfwo_20_d
L_kfwo_20_b:
    s_sub_u32 s33, s33, 16
    s_mul_i32 s33, s33, 204800
    s_add_u32 s38, s38, s33
    s_add_u32 s38, s38, 20480
    s_add_u32 s39, s38, 25600
    buffer_load_ushort v100, v6, s[8:11], s38 offen offset:0
    buffer_load_short_d16_hi v132, v6, s[8:11], s38 offen offset:1280
    buffer_load_ushort v101, v6, s[8:11], s38 offen offset:2560
    buffer_load_short_d16_hi v133, v6, s[8:11], s38 offen offset:3840
    buffer_load_ushort v102, v6, s[8:11], s39 offen offset:0
    buffer_load_short_d16_hi v134, v6, s[8:11], s39 offen offset:1280
    buffer_load_ushort v103, v6, s[8:11], s39 offen offset:2560
    buffer_load_short_d16_hi v135, v6, s[8:11], s39 offen offset:3840
L_kfwo_20_d:
    s_lshl_b32 s42, s2, 2
    s_add_u32 s42, s42, 2
    s_mul_i32 s31, s42, 10486
    s_lshr_b32 s31, s31, 20
    s_mul_i32 s34, s31, 100
    s_sub_u32 s32, s42, s34
    s_mul_i32 s33, s32, 209716
    s_lshr_b32 s33, s33, 20
    s_mul_i32 s34, s33, 5
    s_sub_u32 s38, s32, s34
    s_mul_i32 s31, s31, 160
    s_lshl_b32 s38, s38, 3
    s_add_u32 s38, s38, s31
    s_cmp_ge_u32 s33, 16
    s_cbranch_scc1 L_kfwo_21_b
    s_mul_i32 s33, s33, 51200
    s_add_u32 s38, s38, s33
    s_add_u32 s39, s38, 10240
    buffer_load_ushort v104, v5, s[8:11], s38 offen offset:0
    buffer_load_short_d16_hi v136, v5, s[8:11], s38 offen offset:1280
    buffer_load_ushort v105, v5, s[8:11], s38 offen offset:2560
    buffer_load_short_d16_hi v137, v5, s[8:11], s38 offen offset:3840
    buffer_load_ushort v106, v5, s[8:11], s39 offen offset:0
    buffer_load_short_d16_hi v138, v5, s[8:11], s39 offen offset:1280
    buffer_load_ushort v107, v5, s[8:11], s39 offen offset:2560
    buffer_load_short_d16_hi v139, v5, s[8:11], s39 offen offset:3840
    s_branch L_kfwo_21_d
L_kfwo_21_b:
    s_sub_u32 s33, s33, 16
    s_mul_i32 s33, s33, 204800
    s_add_u32 s38, s38, s33
    s_add_u32 s38, s38, 20480
    s_add_u32 s39, s38, 25600
    buffer_load_ushort v104, v6, s[8:11], s38 offen offset:0
    buffer_load_short_d16_hi v136, v6, s[8:11], s38 offen offset:1280
    buffer_load_ushort v105, v6, s[8:11], s38 offen offset:2560
    buffer_load_short_d16_hi v137, v6, s[8:11], s38 offen offset:3840
    buffer_load_ushort v106, v6, s[8:11], s39 offen offset:0
    buffer_load_short_d16_hi v138, v6, s[8:11], s39 offen offset:1280
    buffer_load_ushort v107, v6, s[8:11], s39 offen offset:2560
    buffer_load_short_d16_hi v139, v6, s[8:11], s39 offen offset:3840
L_kfwo_21_d:
    s_lshl_b32 s42, s2, 2
    s_add_u32 s42, s42, 3
    s_mul_i32 s31, s42, 10486
    s_lshr_b32 s31, s31, 20
    s_mul_i32 s34, s31, 100
    s_sub_u32 s32, s42, s34
    s_mul_i32 s33, s32, 209716
    s_lshr_b32 s33, s33, 20
    s_mul_i32 s34, s33, 5
    s_sub_u32 s38, s32, s34
    s_mul_i32 s31, s31, 160
    s_lshl_b32 s38, s38, 3
    s_add_u32 s38, s38, s31
    s_cmp_ge_u32 s33, 16
    s_cbranch_scc1 L_kfwo_22_b
    s_mul_i32 s33, s33, 51200
    s_add_u32 s38, s38, s33
    s_add_u32 s39, s38, 10240
    buffer_load_ushort v108, v5, s[8:11], s38 offen offset:0
    buffer_load_short_d16_hi v140, v5, s[8:11], s38 offen offset:1280
    buffer_load_ushort v109, v5, s[8:11], s38 offen offset:2560
    buffer_load_short_d16_hi v141, v5, s[8:11], s38 offen offset:3840
    buffer_load_ushort v110, v5, s[8:11], s39 offen offset:0
    buffer_load_short_d16_hi v142, v5, s[8:11], s39 offen offset:1280
    buffer_load_ushort v111, v5, s[8:11], s39 offen offset:2560
    buffer_load_short_d16_hi v143, v5, s[8:11], s39 offen offset:3840
    s_branch L_kfwo_22_d
L_kfwo_22_b:
    s_sub_u32 s33, s33, 16
    s_mul_i32 s33, s33, 204800
    s_add_u32 s38, s38, s33
    s_add_u32 s38, s38, 20480
    s_add_u32 s39, s38, 25600
    buffer_load_ushort v108, v6, s[8:11], s38 offen offset:0
    buffer_load_short_d16_hi v140, v6, s[8:11], s38 offen offset:1280
    buffer_load_ushort v109, v6, s[8:11], s38 offen offset:2560
    buffer_load_short_d16_hi v141, v6, s[8:11], s38 offen offset:3840
    buffer_load_ushort v110, v6, s[8:11], s39 offen offset:0
    buffer_load_short_d16_hi v142, v6, s[8:11], s39 offen offset:1280
    buffer_load_ushort v111, v6, s[8:11], s39 offen offset:2560
    buffer_load_short_d16_hi v143, v6, s[8:11], s39 offen offset:3840
L_kfwo_22_d:
    s_mov_b32 s42, s2
    s_mul_i32 s39, s42, 209716
    s_lshr_b32 s39, s39, 20
    s_mul_i32 s34, s39, 5
    s_sub_u32 s42, s42, s34
    s_lshl_b32 s42, s42, 3
    s_mul_i32 s31, s39, 349526
    s_lshr_b32 s31, s31, 20
    s_mul_i32 s34, s31, 3
    s_sub_u32 s32, s39, s34
    s_mul_i32 s43, s31, 122880
    s_lshl_b32 s32, s32, 10
    s_add_u32 s43, s43, s32
    s_mul_i32 s32, s42, 3072
    s_add_u32 s43, s43, s32
    s_add_u32 s43, s43, 20971520
    s_lshl_b32 s39, s39, 6
    s_mul_i32 s31, s42, 209716
    s_lshr_b32 s31, s31, 20
    s_mul_i32 s34, s31, 5
    s_sub_u32 s32, s42, s34
    s_add_u32 s42, s42, 1
    s_mul_i32 s38, s31, 245760
    s_add_u32 s38, s38, s39
    s_cmp_eq_u32 s32, 4
    s_cbranch_scc1 L_kfw1_23_b
    s_mul_i32 s32, s32, 61440
    s_add_u32 s38, s38, s32
    buffer_load_ushort v32, v8, s[12:15], s38 offen offset:0
    buffer_load_short_d16_hi v64, v8, s[12:15], s38 offen offset:3072
    s_add_u32 s38, s38, 6144
    buffer_load_ushort v33, v8, s[12:15], s38 offen offset:0
    buffer_load_short_d16_hi v65, v8, s[12:15], s38 offen offset:3072
    s_add_u32 s38, s38, 6144
    buffer_load_ushort v34, v8, s[12:15], s38 offen offset:0
    buffer_load_short_d16_hi v66, v8, s[12:15], s38 offen offset:3072
    s_add_u32 s38, s38, 6144
    buffer_load_ushort v35, v8, s[12:15], s38 offen offset:0
    buffer_load_short_d16_hi v67, v8, s[12:15], s38 offen offset:3072
    s_branch L_kfw1_23_d
L_kfw1_23_b:
    s_add_u32 s38, s38, 49152
    buffer_load_ushort v32, v9, s[12:15], s38 offen offset:0
    buffer_load_short_d16_hi v64, v9, s[12:15], s38 offen offset:3072
    s_add_u32 s38, s38, 6144
    buffer_load_ushort v33, v9, s[12:15], s38 offen offset:0
    buffer_load_short_d16_hi v65, v9, s[12:15], s38 offen offset:3072
    s_add_u32 s38, s38, 55296
    buffer_load_ushort v34, v9, s[12:15], s38 offen offset:0
    buffer_load_short_d16_hi v66, v9, s[12:15], s38 offen offset:3072
    s_add_u32 s38, s38, 6144
    buffer_load_ushort v35, v9, s[12:15], s38 offen offset:0
    buffer_load_short_d16_hi v67, v9, s[12:15], s38 offen offset:3072
L_kfw1_23_d:
    s_mul_i32 s31, s42, 209716
    s_lshr_b32 s31, s31, 20
    s_mul_i32 s34, s31, 5
    s_sub_u32 s32, s42, s34
    s_add_u32 s42, s42, 1
    s_mul_i32 s38, s31, 245760
    s_add_u32 s38, s38, s39
    s_cmp_eq_u32 s32, 4
    s_cbranch_scc1 L_kfw1_24_b
    s_mul_i32 s32, s32, 61440
    s_add_u32 s38, s38, s32
    buffer_load_ushort v36, v8, s[12:15], s38 offen offset:0
    buffer_load_short_d16_hi v68, v8, s[12:15], s38 offen offset:3072
    s_add_u32 s38, s38, 6144
    buffer_load_ushort v37, v8, s[12:15], s38 offen offset:0
    buffer_load_short_d16_hi v69, v8, s[12:15], s38 offen offset:3072
    s_add_u32 s38, s38, 6144
    buffer_load_ushort v38, v8, s[12:15], s38 offen offset:0
    buffer_load_short_d16_hi v70, v8, s[12:15], s38 offen offset:3072
    s_add_u32 s38, s38, 6144
    buffer_load_ushort v39, v8, s[12:15], s38 offen offset:0
    buffer_load_short_d16_hi v71, v8, s[12:15], s38 offen offset:3072
    s_branch L_kfw1_24_d
L_kfw1_24_b:
    s_add_u32 s38, s38, 49152
    buffer_load_ushort v36, v9, s[12:15], s38 offen offset:0
    buffer_load_short_d16_hi v68, v9, s[12:15], s38 offen offset:3072
    s_add_u32 s38, s38, 6144
    buffer_load_ushort v37, v9, s[12:15], s38 offen offset:0
    buffer_load_short_d16_hi v69, v9, s[12:15], s38 offen offset:3072
    s_add_u32 s38, s38, 55296
    buffer_load_ushort v38, v9, s[12:15], s38 offen offset:0
    buffer_load_short_d16_hi v70, v9, s[12:15], s38 offen offset:3072
    s_add_u32 s38, s38, 6144
    buffer_load_ushort v39, v9, s[12:15], s38 offen offset:0
    buffer_load_short_d16_hi v71, v9, s[12:15], s38 offen offset:3072
L_kfw1_24_d:
    s_mul_i32 s31, s42, 209716
    s_lshr_b32 s31, s31, 20
    s_mul_i32 s34, s31, 5
    s_sub_u32 s32, s42, s34
    s_add_u32 s42, s42, 1
    s_mul_i32 s38, s31, 245760
    s_add_u32 s38, s38, s39
    s_cmp_eq_u32 s32, 4
    s_cbranch_scc1 L_kfw1_25_b
    s_mul_i32 s32, s32, 61440
    s_add_u32 s38, s38, s32
    buffer_load_ushort v40, v8, s[12:15], s38 offen offset:0
    buffer_load_short_d16_hi v72, v8, s[12:15], s38 offen offset:3072
    s_add_u32 s38, s38, 6144
    buffer_load_ushort v41, v8, s[12:15], s38 offen offset:0
    buffer_load_short_d16_hi v73, v8, s[12:15], s38 offen offset:3072
    s_add_u32 s38, s38, 6144
    buffer_load_ushort v42, v8, s[12:15], s38 offen offset:0
    buffer_load_short_d16_hi v74, v8, s[12:15], s38 offen offset:3072
    s_add_u32 s38, s38, 6144
    buffer_load_ushort v43, v8, s[12:15], s38 offen offset:0
    buffer_load_short_d16_hi v75, v8, s[12:15], s38 offen offset:3072
    s_branch L_kfw1_25_d
L_kfw1_25_b:
    s_add_u32 s38, s38, 49152
    buffer_load_ushort v40, v9, s[12:15], s38 offen offset:0
    buffer_load_short_d16_hi v72, v9, s[12:15], s38 offen offset:3072
    s_add_u32 s38, s38, 6144
    buffer_load_ushort v41, v9, s[12:15], s38 offen offset:0
    buffer_load_short_d16_hi v73, v9, s[12:15], s38 offen offset:3072
    s_add_u32 s38, s38, 55296
    buffer_load_ushort v42, v9, s[12:15], s38 offen offset:0
    buffer_load_short_d16_hi v74, v9, s[12:15], s38 offen offset:3072
    s_add_u32 s38, s38, 6144
    buffer_load_ushort v43, v9, s[12:15], s38 offen offset:0
    buffer_load_short_d16_hi v75, v9, s[12:15], s38 offen offset:3072
L_kfw1_25_d:
    s_mul_i32 s31, s42, 209716
    s_lshr_b32 s31, s31, 20
    s_mul_i32 s34, s31, 5
    s_sub_u32 s32, s42, s34
    s_add_u32 s42, s42, 1
    s_mul_i32 s38, s31, 245760
    s_add_u32 s38, s38, s39
    s_cmp_eq_u32 s32, 4
    s_cbranch_scc1 L_kfw1_26_b
    s_mul_i32 s32, s32, 61440
    s_add_u32 s38, s38, s32
    buffer_load_ushort v44, v8, s[12:15], s38 offen offset:0
    buffer_load_short_d16_hi v76, v8, s[12:15], s38 offen offset:3072
    s_add_u32 s38, s38, 6144
    buffer_load_ushort v45, v8, s[12:15], s38 offen offset:0
    buffer_load_short_d16_hi v77, v8, s[12:15], s38 offen offset:3072
    s_add_u32 s38, s38, 6144
    buffer_load_ushort v46, v8, s[12:15], s38 offen offset:0
    buffer_load_short_d16_hi v78, v8, s[12:15], s38 offen offset:3072
    s_add_u32 s38, s38, 6144
    buffer_load_ushort v47, v8, s[12:15], s38 offen offset:0
    buffer_load_short_d16_hi v79, v8, s[12:15], s38 offen offset:3072
    s_branch L_kfw1_26_d
L_kfw1_26_b:
    s_add_u32 s38, s38, 49152
    buffer_load_ushort v44, v9, s[12:15], s38 offen offset:0
    buffer_load_short_d16_hi v76, v9, s[12:15], s38 offen offset:3072
    s_add_u32 s38, s38, 6144
    buffer_load_ushort v45, v9, s[12:15], s38 offen offset:0
    buffer_load_short_d16_hi v77, v9, s[12:15], s38 offen offset:3072
    s_add_u32 s38, s38, 55296
    buffer_load_ushort v46, v9, s[12:15], s38 offen offset:0
    buffer_load_short_d16_hi v78, v9, s[12:15], s38 offen offset:3072
    s_add_u32 s38, s38, 6144
    buffer_load_ushort v47, v9, s[12:15], s38 offen offset:0
    buffer_load_short_d16_hi v79, v9, s[12:15], s38 offen offset:3072
L_kfw1_26_d:
    s_mul_i32 s31, s42, 209716
    s_lshr_b32 s31, s31, 20
    s_mul_i32 s34, s31, 5
    s_sub_u32 s32, s42, s34
    s_add_u32 s42, s42, 1
    s_mul_i32 s38, s31, 245760
    s_add_u32 s38, s38, s39
    s_cmp_eq_u32 s32, 4
    s_cbranch_scc1 L_kfw1_27_b
    s_mul_i32 s32, s32, 61440
    s_add_u32 s38, s38, s32
    buffer_load_ushort v48, v8, s[12:15], s38 offen offset:0
    buffer_load_short_d16_hi v80, v8, s[12:15], s38 offen offset:3072
    s_add_u32 s38, s38, 6144
    buffer_load_ushort v49, v8, s[12:15], s38 offen offset:0
    buffer_load_short_d16_hi v81, v8, s[12:15], s38 offen offset:3072
    s_add_u32 s38, s38, 6144
    buffer_load_ushort v50, v8, s[12:15], s38 offen offset:0
    buffer_load_short_d16_hi v82, v8, s[12:15], s38 offen offset:3072
    s_add_u32 s38, s38, 6144
    buffer_load_ushort v51, v8, s[12:15], s38 offen offset:0
    buffer_load_short_d16_hi v83, v8, s[12:15], s38 offen offset:3072
    s_branch L_kfw1_27_d
L_kfw1_27_b:
    s_add_u32 s38, s38, 49152
    buffer_load_ushort v48, v9, s[12:15], s38 offen offset:0
    buffer_load_short_d16_hi v80, v9, s[12:15], s38 offen offset:3072
    s_add_u32 s38, s38, 6144
    buffer_load_ushort v49, v9, s[12:15], s38 offen offset:0
    buffer_load_short_d16_hi v81, v9, s[12:15], s38 offen offset:3072
    s_add_u32 s38, s38, 55296
    buffer_load_ushort v50, v9, s[12:15], s38 offen offset:0
    buffer_load_short_d16_hi v82, v9, s[12:15], s38 offen offset:3072
    s_add_u32 s38, s38, 6144
    buffer_load_ushort v51, v9, s[12:15], s38 offen offset:0
    buffer_load_short_d16_hi v83, v9, s[12:15], s38 offen offset:3072
L_kfw1_27_d:
    s_mul_i32 s31, s42, 209716
    s_lshr_b32 s31, s31, 20
    s_mul_i32 s34, s31, 5
    s_sub_u32 s32, s42, s34
    s_add_u32 s42, s42, 1
    s_mul_i32 s38, s31, 245760
    s_add_u32 s38, s38, s39
    s_cmp_eq_u32 s32, 4
    s_cbranch_scc1 L_kfw1_28_b
    s_mul_i32 s32, s32, 61440
    s_add_u32 s38, s38, s32
    buffer_load_ushort v52, v8, s[12:15], s38 offen offset:0
    buffer_load_short_d16_hi v84, v8, s[12:15], s38 offen offset:3072
    s_add_u32 s38, s38, 6144
    buffer_load_ushort v53, v8, s[12:15], s38 offen offset:0
    buffer_load_short_d16_hi v85, v8, s[12:15], s38 offen offset:3072
    s_add_u32 s38, s38, 6144
    buffer_load_ushort v54, v8, s[12:15], s38 offen offset:0
    buffer_load_short_d16_hi v86, v8, s[12:15], s38 offen offset:3072
    s_add_u32 s38, s38, 6144
    buffer_load_ushort v55, v8, s[12:15], s38 offen offset:0
    buffer_load_short_d16_hi v87, v8, s[12:15], s38 offen offset:3072
    s_branch L_kfw1_28_d
L_kfw1_28_b:
    s_add_u32 s38, s38, 49152
    buffer_load_ushort v52, v9, s[12:15], s38 offen offset:0
    buffer_load_short_d16_hi v84, v9, s[12:15], s38 offen offset:3072
    s_add_u32 s38, s38, 6144
    buffer_load_ushort v53, v9, s[12:15], s38 offen offset:0
    buffer_load_short_d16_hi v85, v9, s[12:15], s38 offen offset:3072
    s_add_u32 s38, s38, 55296
    buffer_load_ushort v54, v9, s[12:15], s38 offen offset:0
    buffer_load_short_d16_hi v86, v9, s[12:15], s38 offen offset:3072
    s_add_u32 s38, s38, 6144
    buffer_load_ushort v55, v9, s[12:15], s38 offen offset:0
    buffer_load_short_d16_hi v87, v9, s[12:15], s38 offen offset:3072
L_kfw1_28_d:
    s_mul_i32 s31, s42, 209716
    s_lshr_b32 s31, s31, 20
    s_mul_i32 s34, s31, 5
    s_sub_u32 s32, s42, s34
    s_add_u32 s42, s42, 1
    s_mul_i32 s38, s31, 245760
    s_add_u32 s38, s38, s39
    s_cmp_eq_u32 s32, 4
    s_cbranch_scc1 L_kfw1_29_b
    s_mul_i32 s32, s32, 61440
    s_add_u32 s38, s38, s32
    buffer_load_ushort v56, v8, s[12:15], s38 offen offset:0
    buffer_load_short_d16_hi v88, v8, s[12:15], s38 offen offset:3072
    s_add_u32 s38, s38, 6144
    buffer_load_ushort v57, v8, s[12:15], s38 offen offset:0
    buffer_load_short_d16_hi v89, v8, s[12:15], s38 offen offset:3072
    s_add_u32 s38, s38, 6144
    buffer_load_ushort v58, v8, s[12:15], s38 offen offset:0
    buffer_load_short_d16_hi v90, v8, s[12:15], s38 offen offset:3072
    s_add_u32 s38, s38, 6144
    buffer_load_ushort v59, v8, s[12:15], s38 offen offset:0
    buffer_load_short_d16_hi v91, v8, s[12:15], s38 offen offset:3072
    s_branch L_kfw1_29_d
L_kfw1_29_b:
    s_add_u32 s38, s38, 49152
    buffer_load_ushort v56, v9, s[12:15], s38 offen offset:0
    buffer_load_short_d16_hi v88, v9, s[12:15], s38 offen offset:3072
    s_add_u32 s38, s38, 6144
    buffer_load_ushort v57, v9, s[12:15], s38 offen offset:0
    buffer_load_short_d16_hi v89, v9, s[12:15], s38 offen offset:3072
    s_add_u32 s38, s38, 55296
    buffer_load_ushort v58, v9, s[12:15], s38 offen offset:0
    buffer_load_short_d16_hi v90, v9, s[12:15], s38 offen offset:3072
    s_add_u32 s38, s38, 6144
    buffer_load_ushort v59, v9, s[12:15], s38 offen offset:0
    buffer_load_short_d16_hi v91, v9, s[12:15], s38 offen offset:3072
L_kfw1_29_d:
    s_mul_i32 s31, s42, 209716
    s_lshr_b32 s31, s31, 20
    s_mul_i32 s34, s31, 5
    s_sub_u32 s32, s42, s34
    s_add_u32 s42, s42, 1
    s_mul_i32 s38, s31, 245760
    s_add_u32 s38, s38, s39
    s_cmp_eq_u32 s32, 4
    s_cbranch_scc1 L_kfw1_30_b
    s_mul_i32 s32, s32, 61440
    s_add_u32 s38, s38, s32
    buffer_load_ushort v60, v8, s[12:15], s38 offen offset:0
    buffer_load_short_d16_hi v92, v8, s[12:15], s38 offen offset:3072
    s_add_u32 s38, s38, 6144
    buffer_load_ushort v61, v8, s[12:15], s38 offen offset:0
    buffer_load_short_d16_hi v93, v8, s[12:15], s38 offen offset:3072
    s_add_u32 s38, s38, 6144
    buffer_load_ushort v62, v8, s[12:15], s38 offen offset:0
    buffer_load_short_d16_hi v94, v8, s[12:15], s38 offen offset:3072
    s_add_u32 s38, s38, 6144
    buffer_load_ushort v63, v8, s[12:15], s38 offen offset:0
    buffer_load_short_d16_hi v95, v8, s[12:15], s38 offen offset:3072
    s_branch L_kfw1_30_d
L_kfw1_30_b:
    s_add_u32 s38, s38, 49152
    buffer_load_ushort v60, v9, s[12:15], s38 offen offset:0
    buffer_load_short_d16_hi v92, v9, s[12:15], s38 offen offset:3072
    s_add_u32 s38, s38, 6144
    buffer_load_ushort v61, v9, s[12:15], s38 offen offset:0
    buffer_load_short_d16_hi v93, v9, s[12:15], s38 offen offset:3072
    s_add_u32 s38, s38, 55296
    buffer_load_ushort v62, v9, s[12:15], s38 offen offset:0
    buffer_load_short_d16_hi v94, v9, s[12:15], s38 offen offset:3072
    s_add_u32 s38, s38, 6144
    buffer_load_ushort v63, v9, s[12:15], s38 offen offset:0
    buffer_load_short_d16_hi v95, v9, s[12:15], s38 offen offset:3072
L_kfw1_30_d:
    s_cmp_ge_u32 s2, 200
    s_cbranch_scc1 L_kf_nowo
    s_lshl_b32 s31, s2, 12
    s_add_u32 s31, s31, 19922944
    s_waitcnt vmcnt(63)
    v_and_or_b32 v96, v128, s40, v96
    v_and_or_b32 v97, v129, s40, v97
    v_and_or_b32 v98, v130, s40, v98
    v_and_or_b32 v99, v131, s40, v99
    buffer_store_dwordx4 v[96:99], v10, s[16:19], s31 offen offset:0 sc1
    v_and_or_b32 v100, v132, s40, v100
    v_and_or_b32 v101, v133, s40, v101
    v_and_or_b32 v102, v134, s40, v102
    v_and_or_b32 v103, v135, s40, v103
    buffer_store_dwordx4 v[100:103], v10, s[16:19], s31 offen offset:1024 sc1
    v_and_or_b32 v104, v136, s40, v104
    v_and_or_b32 v105, v137, s40, v105
    v_and_or_b32 v106, v138, s40, v106
    v_and_or_b32 v107, v139, s40, v107
    buffer_store_dwordx4 v[104:107], v10, s[16:19], s31 offen offset:2048 sc1
    v_and_or_b32 v108, v140, s40, v108
    v_and_or_b32 v109, v141, s40, v109
    v_and_or_b32 v110, v142, s40, v110
    v_and_or_b32 v111, v143, s40, v111
    buffer_store_dwordx4 v[108:111], v10, s[16:19], s31 offen offset:3072 sc1
L_kf_nowo:
    s_cmp_ge_u32 s2, 240
    s_cbranch_scc1 L_kf_now1
    s_waitcnt vmcnt(0)
    v_and_or_b32 v32, v64, s40, v32
    v_and_or_b32 v33, v65, s40, v33
    v_and_or_b32 v34, v66, s40, v34
    v_and_or_b32 v35, v67, s40, v35
    buffer_store_dwordx4 v[32:35], v10, s[16:19], s43 offen sc1
    s_add_u32 s43, s43, 3072
    v_dot2c_f32_bf16 v14, s41, v32
    v_dot2c_f32_bf16 v14, s41, v33
    v_dot2c_f32_bf16 v14, s41, v34
    v_dot2c_f32_bf16 v14, s41, v35
    v_and_or_b32 v36, v68, s40, v36
    v_and_or_b32 v37, v69, s40, v37
    v_and_or_b32 v38, v70, s40, v38
    v_and_or_b32 v39, v71, s40, v39
    buffer_store_dwordx4 v[36:39], v10, s[16:19], s43 offen sc1
    s_add_u32 s43, s43, 3072
    v_dot2c_f32_bf16 v14, s41, v36
    v_dot2c_f32_bf16 v14, s41, v37
    v_dot2c_f32_bf16 v14, s41, v38
    v_dot2c_f32_bf16 v14, s41, v39
    v_and_or_b32 v40, v72, s40, v40
    v_and_or_b32 v41, v73, s40, v41
    v_and_or_b32 v42, v74, s40, v42
    v_and_or_b32 v43, v75, s40, v43
    buffer_store_dwordx4 v[40:43], v10, s[16:19], s43 offen sc1
    s_add_u32 s43, s43, 3072
    v_dot2c_f32_bf16 v14, s41, v40
    v_dot2c_f32_bf16 v14, s41, v41
    v_dot2c_f32_bf16 v14, s41, v42
    v_dot2c_f32_bf16 v14, s41, v43
    v_and_or_b32 v44, v76, s40, v44
    v_and_or_b32 v45, v77, s40, v45
    v_and_or_b32 v46, v78, s40, v46
    v_and_or_b32 v47, v79, s40, v47
    buffer_store_dwordx4 v[44:47], v10, s[16:19], s43 offen sc1
    s_add_u32 s43, s43, 3072
    v_dot2c_f32_bf16 v14, s41, v44
    v_dot2c_f32_bf16 v14, s41, v45
    v_dot2c_f32_bf16 v14, s41, v46
    v_dot2c_f32_bf16 v14, s41, v47
    v_and_or_b32 v48, v80, s40, v48
    v_and_or_b32 v49, v81, s40, v49
    v_and_or_b32 v50, v82, s40, v50
    v_and_or_b32 v51, v83, s40, v51
    buffer_store_dwordx4 v[48:51], v10, s[16:19], s43 offen sc1
    s_add_u32 s43, s43, 3072
    v_dot2c_f32_bf16 v14, s41, v48
    v_dot2c_f32_bf16 v14, s41, v49
    v_dot2c_f32_bf16 v14, s41, v50
    v_dot2c_f32_bf16 v14, s41, v51
    v_and_or_b32 v52, v84, s40, v52
    v_and_or_b32 v53, v85, s40, v53
    v_and_or_b32 v54, v86, s40, v54
    v_and_or_b32 v55, v87, s40, v55
    buffer_store_dwordx4 v[52:55], v10, s[16:19], s43 offen sc1
    s_add_u32 s43, s43, 3072
    v_dot2c_f32_bf16 v14, s41, v52
    v_dot2c_f32_bf16 v14, s41, v53
    v_dot2c_f32_bf16 v14, s41, v54
    v_dot2c_f32_bf16 v14, s41, v55
    v_and_or_b32 v56, v88, s40, v56
    v_and_or_b32 v57, v89, s40, v57
    v_and_or_b32 v58, v90, s40, v58
    v_and_or_b32 v59, v91, s40, v59
    buffer_store_dwordx4 v[56:59], v10, s[16:19], s43 offen sc1
    s_add_u32 s43, s43, 3072
    v_dot2c_f32_bf16 v14, s41, v56
    v_dot2c_f32_bf16 v14, s41, v57
    v_dot2c_f32_bf16 v14, s41, v58
    v_dot2c_f32_bf16 v14, s41, v59
    v_and_or_b32 v60, v92, s40, v60
    v_and_or_b32 v61, v93, s40, v61
    v_and_or_b32 v62, v94, s40, v62
    v_and_or_b32 v63, v95, s40, v63
    buffer_store_dwordx4 v[60:63], v10, s[16:19], s43 offen sc1
    s_add_u32 s43, s43, 3072
    v_dot2c_f32_bf16 v14, s41, v60
    v_dot2c_f32_bf16 v14, s41, v61
    v_dot2c_f32_bf16 v14, s41, v62
    v_dot2c_f32_bf16 v14, s41, v63
    s_nop 2
    v_mov_b32 v27, v14
    s_nop 1
    v_permlane32_swap_b32 v14, v27
    s_lshl_b32 s31, s2, 7
    s_add_u32 s31, s31, 25690112
    v_add_f32 v14, v14, v27
    v_lshlrev_b32 v27, 2, v2
    buffer_store_dword v14, v27, s[16:19], s31 offen sc1
L_kf_now1:
    s_lshl_b32 s42, s2, 3
    s_mul_i32 s31, s42, 4370
    s_lshr_b32 s31, s31, 20
    s_mul_i32 s34, s31, 240
    s_sub_u32 s32, s42, s34
    s_mul_i32 s33, s32, 209716
    s_lshr_b32 s33, s33, 20
    s_mul_i32 s34, s33, 5
    s_sub_u32 s38, s32, s34
    s_mul_i32 s31, s31, 160
    s_lshl_b32 s38, s38, 3
    s_add_u32 s38, s38, s31
    s_mul_i32 s33, s33, 40960
    s_add_u32 s38, s38, s33
    s_add_u32 s39, s38, 10240
    buffer_load_ushort v96, v7, s[20:23], s38 offen offset:0
    buffer_load_short_d16_hi v128, v7, s[20:23], s38 offen offset:1280
    buffer_load_ushort v97, v7, s[20:23], s38 offen offset:2560
    buffer_load_short_d16_hi v129, v7, s[20:23], s38 offen offset:3840
    buffer_load_ushort v98, v7, s[20:23], s39 offen offset:0
    buffer_load_short_d16_hi v130, v7, s[20:23], s39 offen offset:1280
    buffer_load_ushort v99, v7, s[20:23], s39 offen offset:2560
    buffer_load_short_d16_hi v131, v7, s[20:23], s39 offen offset:3840
    s_lshl_b32 s42, s2, 3
    s_add_u32 s42, s42, 1
    s_mul_i32 s31, s42, 4370
    s_lshr_b32 s31, s31, 20
    s_mul_i32 s34, s31, 240
    s_sub_u32 s32, s42, s34
    s_mul_i32 s33, s32, 209716
    s_lshr_b32 s33, s33, 20
    s_mul_i32 s34, s33, 5
    s_sub_u32 s38, s32, s34
    s_mul_i32 s31, s31, 160
    s_lshl_b32 s38, s38, 3
    s_add_u32 s38, s38, s31
    s_mul_i32 s33, s33, 40960
    s_add_u32 s38, s38, s33
    s_add_u32 s39, s38, 10240
    buffer_load_ushort v100, v7, s[20:23], s38 offen offset:0
    buffer_load_short_d16_hi v132, v7, s[20:23], s38 offen offset:1280
    buffer_load_ushort v101, v7, s[20:23], s38 offen offset:2560
    buffer_load_short_d16_hi v133, v7, s[20:23], s38 offen offset:3840
    buffer_load_ushort v102, v7, s[20:23], s39 offen offset:0
    buffer_load_short_d16_hi v134, v7, s[20:23], s39 offen offset:1280
    buffer_load_ushort v103, v7, s[20:23], s39 offen offset:2560
    buffer_load_short_d16_hi v135, v7, s[20:23], s39 offen offset:3840
    s_lshl_b32 s42, s2, 3
    s_add_u32 s42, s42, 2
    s_mul_i32 s31, s42, 4370
    s_lshr_b32 s31, s31, 20
    s_mul_i32 s34, s31, 240
    s_sub_u32 s32, s42, s34
    s_mul_i32 s33, s32, 209716
    s_lshr_b32 s33, s33, 20
    s_mul_i32 s34, s33, 5
    s_sub_u32 s38, s32, s34
    s_mul_i32 s31, s31, 160
    s_lshl_b32 s38, s38, 3
    s_add_u32 s38, s38, s31
    s_mul_i32 s33, s33, 40960
    s_add_u32 s38, s38, s33
    s_add_u32 s39, s38, 10240
    buffer_load_ushort v104, v7, s[20:23], s38 offen offset:0
    buffer_load_short_d16_hi v136, v7, s[20:23], s38 offen offset:1280
    buffer_load_ushort v105, v7, s[20:23], s38 offen offset:2560
    buffer_load_short_d16_hi v137, v7, s[20:23], s38 offen offset:3840
    buffer_load_ushort v106, v7, s[20:23], s39 offen offset:0
    buffer_load_short_d16_hi v138, v7, s[20:23], s39 offen offset:1280
    buffer_load_ushort v107, v7, s[20:23], s39 offen offset:2560
    buffer_load_short_d16_hi v139, v7, s[20:23], s39 offen offset:3840
    s_lshl_b32 s42, s2, 3
    s_add_u32 s42, s42, 3
    s_mul_i32 s31, s42, 4370
    s_lshr_b32 s31, s31, 20
    s_mul_i32 s34, s31, 240
    s_sub_u32 s32, s42, s34
    s_mul_i32 s33, s32, 209716
    s_lshr_b32 s33, s33, 20
    s_mul_i32 s34, s33, 5
    s_sub_u32 s38, s32, s34
    s_mul_i32 s31, s31, 160
    s_lshl_b32 s38, s38, 3
    s_add_u32 s38, s38, s31
    s_mul_i32 s33, s33, 40960
    s_add_u32 s38, s38, s33
    s_add_u32 s39, s38, 10240
    buffer_load_ushort v108, v7, s[20:23], s38 offen offset:0
    buffer_load_short_d16_hi v140, v7, s[20:23], s38 offen offset:1280
    buffer_load_ushort v109, v7, s[20:23], s38 offen offset:2560
    buffer_load_short_d16_hi v141, v7, s[20:23], s38 offen offset:3840
    buffer_load_ushort v110, v7, s[20:23], s39 offen offset:0
    buffer_load_short_d16_hi v142, v7, s[20:23], s39 offen offset:1280
    buffer_load_ushort v111, v7, s[20:23], s39 offen offset:2560
    buffer_load_short_d16_hi v143, v7, s[20:23], s39 offen offset:3840
    s_lshl_b32 s42, s2, 3
    s_add_u32 s42, s42, 4
    s_mul_i32 s31, s42, 4370
    s_lshr_b32 s31, s31, 20
    s_mul_i32 s34, s31, 240
    s_sub_u32 s32, s42, s34
    s_mul_i32 s33, s32, 209716
    s_lshr_b32 s33, s33, 20
    s_mul_i32 s34, s33, 5
    s_sub_u32 s38, s32, s34
    s_mul_i32 s31, s31, 160
    s_lshl_b32 s38, s38, 3
    s_add_u32 s38, s38, s31
    s_mul_i32 s33, s33, 40960
    s_add_u32 s38, s38, s33
    s_add_u32 s39, s38, 10240
    buffer_load_ushort v112, v7, s[20:23], s38 offen offset:0
    buffer_load_short_d16_hi v144, v7, s[20:23], s38 offen offset:1280
    buffer_load_ushort v113, v7, s[20:23], s38 offen offset:2560
    buffer_load_short_d16_hi v145, v7, s[20:23], s38 offen offset:3840
    buffer_load_ushort v114, v7, s[20:23], s39 offen offset:0
    buffer_load_short_d16_hi v146, v7, s[20:23], s39 offen offset:1280
    buffer_load_ushort v115, v7, s[20:23], s39 offen offset:2560
    buffer_load_short_d16_hi v147, v7, s[20:23], s39 offen offset:3840
    s_lshl_b32 s42, s2, 3
    s_add_u32 s42, s42, 5
    s_mul_i32 s31, s42, 4370
    s_lshr_b32 s31, s31, 20
    s_mul_i32 s34, s31, 240
    s_sub_u32 s32, s42, s34
    s_mul_i32 s33, s32, 209716
    s_lshr_b32 s33, s33, 20
    s_mul_i32 s34, s33, 5
    s_sub_u32 s38, s32, s34
    s_mul_i32 s31, s31, 160
    s_lshl_b32 s38, s38, 3
    s_add_u32 s38, s38, s31
    s_mul_i32 s33, s33, 40960
    s_add_u32 s38, s38, s33
    s_add_u32 s39, s38, 10240
    buffer_load_ushort v116, v7, s[20:23], s38 offen offset:0
    buffer_load_short_d16_hi v148, v7, s[20:23], s38 offen offset:1280
    buffer_load_ushort v117, v7, s[20:23], s38 offen offset:2560
    buffer_load_short_d16_hi v149, v7, s[20:23], s38 offen offset:3840
    buffer_load_ushort v118, v7, s[20:23], s39 offen offset:0
    buffer_load_short_d16_hi v150, v7, s[20:23], s39 offen offset:1280
    buffer_load_ushort v119, v7, s[20:23], s39 offen offset:2560
    buffer_load_short_d16_hi v151, v7, s[20:23], s39 offen offset:3840
    s_lshl_b32 s42, s2, 3
    s_add_u32 s42, s42, 6
    s_mul_i32 s31, s42, 4370
    s_lshr_b32 s31, s31, 20
    s_mul_i32 s34, s31, 240
    s_sub_u32 s32, s42, s34
    s_mul_i32 s33, s32, 209716
    s_lshr_b32 s33, s33, 20
    s_mul_i32 s34, s33, 5
    s_sub_u32 s38, s32, s34
    s_mul_i32 s31, s31, 160
    s_lshl_b32 s38, s38, 3
    s_add_u32 s38, s38, s31
    s_mul_i32 s33, s33, 40960
    s_add_u32 s38, s38, s33
    s_add_u32 s39, s38, 10240
    buffer_load_ushort v120, v7, s[20:23], s38 offen offset:0
    buffer_load_short_d16_hi v152, v7, s[20:23], s38 offen offset:1280
    buffer_load_ushort v121, v7, s[20:23], s38 offen offset:2560
    buffer_load_short_d16_hi v153, v7, s[20:23], s38 offen offset:3840
    buffer_load_ushort v122, v7, s[20:23], s39 offen offset:0
    buffer_load_short_d16_hi v154, v7, s[20:23], s39 offen offset:1280
    buffer_load_ushort v123, v7, s[20:23], s39 offen offset:2560
    buffer_load_short_d16_hi v155, v7, s[20:23], s39 offen offset:3840
    s_lshl_b32 s43, s2, 2
    s_add_u32 s43, s43, 26214400
    s_getreg_b32 s63, hwreg(HW_REG_XCC_ID)
    s_and_b32 s63, s63, 15
    s_add_u32 s63, s63, 1
    v_mov_b32 v27, 0
    v_mov_b32 v28, s63
    s_waitcnt vmcnt(56)
    s_mov_b64 exec, 1
    buffer_store_dword v28, v27, s[16:19], s43 offen sc1
    s_mov_b64 exec, -1
    s_lshl_b32 s42, s2, 3
    s_add_u32 s42, s42, 7
    s_mul_i32 s31, s42, 4370
    s_lshr_b32 s31, s31, 20
    s_mul_i32 s34, s31, 240
    s_sub_u32 s32, s42, s34
    s_mul_i32 s33, s32, 209716
    s_lshr_b32 s33, s33, 20
    s_mul_i32 s34, s33, 5
    s_sub_u32 s38, s32, s34
    s_mul_i32 s31, s31, 160
    s_lshl_b32 s38, s38, 3
    s_add_u32 s38, s38, s31
    s_mul_i32 s33, s33, 40960
    s_add_u32 s38, s38, s33
    s_add_u32 s39, s38, 10240
    buffer_load_ushort v124, v7, s[20:23], s38 offen offset:0
    buffer_load_short_d16_hi v156, v7, s[20:23], s38 offen offset:1280
    buffer_load_ushort v125, v7, s[20:23], s38 offen offset:2560
    buffer_load_short_d16_hi v157, v7, s[20:23], s38 offen offset:3840
    buffer_load_ushort v126, v7, s[20:23], s39 offen offset:0
    buffer_load_short_d16_hi v158, v7, s[20:23], s39 offen offset:1280
    buffer_load_ushort v127, v7, s[20:23], s39 offen offset:2560
    buffer_load_short_d16_hi v159, v7, s[20:23], s39 offen offset:3840
    s_cmp_ge_u32 s2, 240
    s_cbranch_scc1 L_kf_now2
    s_lshl_b32 s31, s2, 13
    s_add_u32 s31, s31, 23068672
    s_waitcnt vmcnt(0)
    v_and_or_b32 v96, v128, s40, v96
    v_and_or_b32 v97, v129, s40, v97
    v_and_or_b32 v98, v130, s40, v98
    v_and_or_b32 v99, v131, s40, v99
    buffer_store_dwordx4 v[96:99], v10, s[16:19], s31 offen offset:0 sc1
    v_and_or_b32 v100, v132, s40, v100
    v_and_or_b32 v101, v133, s40, v101
    v_and_or_b32 v102, v134, s40, v102
    v_and_or_b32 v103, v135, s40, v103
    buffer_store_dwordx4 v[100:103], v10, s[16:19], s31 offen offset:1024 sc1
    v_and_or_b32 v104, v136, s40, v104
    v_and_or_b32 v105, v137, s40, v105
    v_and_or_b32 v106, v138, s40, v106
    v_and_or_b32 v107, v139, s40, v107
    buffer_store_dwordx4 v[104:107], v10, s[16:19], s31 offen offset:2048 sc1
    v_and_or_b32 v108, v140, s40, v108
    v_and_or_b32 v109, v141, s40, v109
    v_and_or_b32 v110, v142, s40, v110
    v_and_or_b32 v111, v143, s40, v111
    buffer_store_dwordx4 v[108:111], v10, s[16:19], s31 offen offset:3072 sc1
    v_and_or_b32 v112, v144, s40, v112
    v_and_or_b32 v113, v145, s40, v113
    v_and_or_b32 v114, v146, s40, v114
    v_and_or_b32 v115, v147, s40, v115
    s_add_u32 s31, s31, 4096
    buffer_store_dwordx4 v[112:115], v10, s[16:19], s31 offen offset:0 sc1
    v_and_or_b32 v116, v148, s40, v116
    v_and_or_b32 v117, v149, s40, v117
    v_and_or_b32 v118, v150, s40, v118
    v_and_or_b32 v119, v151, s40, v119
    buffer_store_dwordx4 v[116:119], v10, s[16:19], s31 offen offset:1024 sc1
    v_and_or_b32 v120, v152, s40, v120
    v_and_or_b32 v121, v153, s40, v121
    v_and_or_b32 v122, v154, s40, v122
    v_and_or_b32 v123, v155, s40, v123
    buffer_store_dwordx4 v[120:123], v10, s[16:19], s31 offen offset:2048 sc1
    v_and_or_b32 v124, v156, s40, v124
    v_and_or_b32 v125, v157, s40, v125
    v_and_or_b32 v126, v158, s40, v126
    v_and_or_b32 v127, v159, s40, v127
    buffer_store_dwordx4 v[124:127], v10, s[16:19], s31 offen offset:3072 sc1
L_kf_now2:
    s_add_u32 s43, s43, 0x400
    v_mov_b32 v27, 0
    v_mov_b32 v28, 1
    s_waitcnt vmcnt(0)
    s_mov_b64 exec, 1
    buffer_store_dword v28, v27, s[16:19], s43 offen sc1
    s_mov_b64 exec, -1
    s_mov_b32 s31, 26214400
    s_mov_b32 s54, 200000
L_poll_31:
    buffer_load_dwordx4 v[32:35], v10, s[16:19], s31 offen sc1
    s_waitcnt vmcnt(0)
    v_min_u32 v32, v32, v33
    v_min3_u32 v32, v32, v34, v35
    v_cmp_eq_u32 vcc, 0, v32
    s_sub_u32 s54, s54, 1
    s_cbranch_vccz L_poll_31_d
    s_cbranch_scc1 L_poll_31_d
    s_sleep 1
    s_branch L_poll_31
L_poll_31_d:
    v_mul_u32_u24 v27, 640, v3
    v_lshl_add_u32 v27, v2, 2, v27
    s_mul_i32 s31, s59, 1920
    s_add_u32 s31, s31, 25690112
    buffer_load_dword v32, v27, s[16:19], s31 offen offset:0 sc1
    buffer_load_dword v40, v27, s[16:19], s31 offen offset:1280 sc1
    buffer_load_dword v33, v27, s[16:19], s31 offen offset:128 sc1
    buffer_load_dword v41, v27, s[16:19], s31 offen offset:1408 sc1
    buffer_load_dword v34, v27, s[16:19], s31 offen offset:256 sc1
    buffer_load_dword v42, v27, s[16:19], s31 offen offset:1536 sc1
    buffer_load_dword v35, v27, s[16:19], s31 offen offset:384 sc1
    buffer_load_dword v43, v27, s[16:19], s31 offen offset:1664 sc1
    buffer_load_dword v36, v27, s[16:19], s31 offen offset:512 sc1
    buffer_load_dword v44, v27, s[16:19], s31 offen offset:1792 sc1
    v_lshlrev_b32 v28, 5, v2
    s_lshl_b32 s31, s52, 2
    s_add_u32 s31, s31, 26214400
    buffer_load_dword v46, v28, s[16:19], s31 offen sc1
    v_lshlrev_b32 v28, 7, v1
    s_mul_i32 s31, s53, 61440
    s_add_u32 s31, s31, 20971520
    buffer_load_dword v48, v28, s[16:19], s31 offen
    s_add_u32 s31, s31, 8192
    buffer_load_dword v48, v28, s[16:19], s31 offen
    s_add_u32 s31, s31, 8192
    buffer_load_dword v48, v28, s[16:19], s31 offen
    s_add_u32 s31, s31, 8192
    buffer_load_dword v48, v28, s[16:19], s31 offen
    s_add_u32 s31, s31, 8192
    buffer_load_dword v48, v28, s[16:19], s31 offen
    s_add_u32 s31, s31, 8192
    buffer_load_dword v48, v28, s[16:19], s31 offen
    s_add_u32 s31, s31, 8192
    buffer_load_dword v48, v28, s[16:19], s31 offen
    s_add_u32 s31, s31, 8192
    s_mov_b32 exec_lo, 0xffffffff
    s_mov_b32 exec_hi, 0x0
    buffer_load_dword v48, v28, s[16:19], s31 offen
    s_add_u32 s31, s31, 8192
    s_mov_b64 exec, -1
    s_waitcnt vmcnt(8)
    v_cmp_ne_u32 vcc, s63, v46
    s_cmp_eq_u64 vcc, 0
    s_cselect_b32 s63, 1, 0
    v_mov_b32 v15, s63
    s_cmp_eq_u32 s63, 1
    s_cbranch_scc0 L_kf_notouch
    s_lshl_b32 s31, s52, 5
    s_add_u32 s31, s31, s53
    s_mul_i32 s31, s31, 10240
    s_add_u32 s31, s31, 10485760
    buffer_load_dword v48, v28, s[16:19], s31 offen sc1
    s_add_u32 s31, s31, 8192
    s_mov_b32 exec_lo, 0xffff
    s_mov_b32 exec_hi, 0x0
    buffer_load_dword v48, v28, s[16:19], s31 offen sc1
    s_add_u32 s31, s31, 8192
    s_mov_b64 exec, -1
    s_lshl_b32 s31, s52, 5
    s_add_u32 s31, s31, s53
    s_mul_i32 s31, s31, 24576
    s_add_u32 s31, s31, 13631488
    buffer_load_dword v48, v28, s[16:19], s31 offen sc1
    s_add_u32 s31, s31, 8192
    buffer_load_dword v48, v28, s[16:19], s31 offen sc1
    s_add_u32 s31, s31, 8192
    buffer_load_dword v48, v28, s[16:19], s31 offen sc1
    s_add_u32 s31, s31, 8192
    s_mov_b64 exec, -1
    s_lshl_b32 s31, s52, 5
    s_add_u32 s31, s31, s53
    s_mul_i32 s31, s31, 512
    s_add_u32 s31, s31, 13107200
    s_mov_b32 exec_lo, 0xf
    s_mov_b32 exec_hi, 0x0
    buffer_load_dword v48, v28, s[16:19], s31 offen sc1
    s_add_u32 s31, s31, 8192
    s_mov_b64 exec, -1
L_kf_notouch:
    v_add_f32 v12, v32, v33
    v_add_f32 v34, v34, v35
    v_add_f32 v12, v12, v36
    v_add_f32 v12, v12, v34
    v_add_f32 v13, v40, v41
    v_add_f32 v42, v42, v43
    v_add_f32 v13, v13, v44
    v_add_f32 v13, v13, v42
    v_lshlrev_b32 v27, 2, v1
    v_add_u32 v27, 162816, v27
    v_lshlrev_b32 v29, 2, v1
    s_lshl_b32 s56, s52, 2
    s_and_b32 s31, s53, 3
    s_add_u32 s56, s56, s31
    s_lshl_b32 s58, s52, 1
    s_and_b32 s31, s53, 1
    s_add_u32 s58, s58, s31
    s_mul_i32 s38, s57, 102400
    s_add_u32 s38, s38, 19922944
    v_add_u32 v11, 4096, v10
    s_barrier
    s_add_u32 s33, s60, 0
    s_mov_b32 m0, 30720
    s_mov_b32 s31, 6
    s_mul_i32 s33, s33, 5120
L_run_32:
    s_sub_u32 s34, s33, 102400
    s_cselect_b32 s33, s33, s34
    s_add_u32 s34, s33, s38
    s_add_u32 s33, s33, 5120
    buffer_load_dwordx4 v10, s[16:19], s34 offen offset:0  lds
    buffer_load_dwordx4 v10, s[16:19], s34 offen offset:1024  lds
    buffer_load_dwordx4 v10, s[16:19], s34 offen offset:2048  lds
    buffer_load_dwordx4 v10, s[16:19], s34 offen offset:3072  lds
    s_add_u32 m0, m0, 4096
    s_sub_u32 s31, s31, 1
    buffer_load_dwordx4 v11, s[16:19], s34 offen  lds
    s_add_u32 m0, m0, 1024
    s_cmp_lg_u32 s31, 0
    s_cbranch_scc1 L_run_32
L_run_32_e:
    s_add_u32 s33, s60, 6
    s_mov_b32 m0, 81920
    s_mov_b32 s31, 12
    s_mul_i32 s33, s33, 5120
L_run_33:
    s_sub_u32 s34, s33, 102400
    s_cselect_b32 s33, s33, s34
    s_add_u32 s34, s33, s38
    s_add_u32 s33, s33, 5120
    buffer_load_dwordx4 v10, s[16:19], s34 offen offset:0  lds
    buffer_load_dwordx4 v10, s[16:19], s34 offen offset:1024  lds
    buffer_load_dwordx4 v10, s[16:19], s34 offen offset:2048  lds
    buffer_load_dwordx4 v10, s[16:19], s34 offen offset:3072  lds
    s_add_u32 m0, m0, 4096
    s_sub_u32 s31, s31, 1
    buffer_load_dwordx4 v11, s[16:19], s34 offen  lds
    s_add_u32 m0, m0, 1024
    s_cmp_lg_u32 s31, 0
    s_cbranch_scc1 L_run_33
L_run_33_e:
    s_mov_b32 s31, 26215424
    s_mov_b32 s54, 200000
L_poll_34:
    buffer_load_dwordx4 v[52:55], v10, s[16:19], s31 offen sc1
    s_waitcnt vmcnt(0)
    v_min_u32 v52, v52, v53
    v_min3_u32 v52, v52, v54, v55
    v_cmp_eq_u32 vcc, 0, v52
    s_sub_u32 s54, s54, 1
    s_cbranch_vccz L_poll_34_d
    s_cbranch_scc1 L_poll_34_d
    s_sleep 1
    s_branch L_poll_34
L_poll_34_d:
    s_mul_i32 s39, s59, 122880
    s_add_u32 s39, s39, 20971520
    s_barrier
    s_barrier
    ds_write_b32 v27, v12
    s_mov_b64 exec, 0xffffffff
    ds_write_b32 v27, v13 offset:256
    ds_write_b32 v27, v15 offset:384
    s_mov_b64 exec, -1
    s_add_u32 s33, s60, 18
    s_mov_b32 m0, 61440
    s_mov_b32 s31, 2
    s_mul_i32 s33, s33, 5120
L_run_35:
    s_sub_u32 s34, s33, 102400
    s_cselect_b32 s33, s33, s34
    s_add_u32 s34, s33, s38
    s_add_u32 s33, s33, 5120
    buffer_load_dwordx4 v10, s[16:19], s34 offen offset:0  lds
    buffer_load_dwordx4 v10, s[16:19], s34 offen offset:1024  lds
    buffer_load_dwordx4 v10, s[16:19], s34 offen offset:2048  lds
    buffer_load_dwordx4 v10, s[16:19], s34 offen offset:3072  lds
    s_add_u32 m0, m0, 4096
    s_sub_u32 s31, s31, 1
    buffer_load_dwordx4 v11, s[16:19], s34 offen  lds
    s_add_u32 m0, m0, 1024
    s_cmp_lg_u32 s31, 0
    s_cbranch_scc1 L_run_35
L_run_35_e:
    s_lshl_b32 s31, s56, 11
    s_add_u32 s31, s31, 26247168
    v_lshrrev_b32 v30, 2, v1
    v_lshlrev_b32 v30, 7, v30
    v_and_b32 v28, 3, v1
    v_lshl_add_u32 v30, v28, 2, v30
    s_waitcnt lgkmcnt(0)
    s_mov_b32 s54, 200000
L_poll_36:
    buffer_load_dword v32, v30, s[16:19], s31 offen sc1
    s_waitcnt vmcnt(0)
    v_cmp_eq_u32 vcc, 0, v32
    s_sub_u32 s54, s54, 1
    s_cbranch_vccz L_poll_36_d
    s_cbranch_scc1 L_poll_36_d
    s_sleep 1
    s_branch L_poll_36
L_poll_36_d:
    s_barrier
    s_barrier
    s_barrier
    s_lshl_b32 s31, s58, 8
    s_add_u32 s31, s31, 26230784
    s_mov_b32 s54, 200000
L_poll_37:
    buffer_load_dword v32, v29, s[16:19], s31 offen sc1
    s_waitcnt vmcnt(0)
    v_cmp_eq_u32 vcc, 0, v32
    s_sub_u32 s54, s54, 1
    s_cbranch_vccz L_poll_37_d
    s_cbranch_scc1 L_poll_37_d
    s_sleep 1
    s_branch L_poll_37
L_poll_37_d:
    s_barrier
    s_barrier
    s_barrier
    s_lshl_b32 s31, s56, 7
    s_add_u32 s31, s31, 26238976
    s_mov_b32 s54, 200000
    s_mov_b64 exec, 0xffffffff
L_poll_38:
    buffer_load_dword v32, v29, s[16:19], s31 offen sc1
    s_waitcnt vmcnt(0)
    v_cmp_eq_u32 vcc, 0, v32
    s_sub_u32 s54, s54, 1
    s_cbranch_vccz L_poll_38_d
    s_cbranch_scc1 L_poll_38_d
    s_sleep 1
    s_branch L_poll_38
L_poll_38_d:
    s_mov_b64 exec, -1
    s_mul_i32 s38, s57, 245760
    s_add_u32 s38, s38, 23068672
    s_barrier
    s_barrier
    s_add_u32 s33, s62, 30
    s_mov_b32 m0, 115712
    s_mov_b32 s31, 5
    s_mul_i32 s33, s33, 5120
L_run_39:
    s_sub_u32 s34, s33, 245760
    s_cselect_b32 s33, s33, s34
    s_add_u32 s34, s33, s38
    s_add_u32 s33, s33, 5120
    buffer_load_dwordx4 v10, s[16:19], s34 offen offset:0  lds
    buffer_load_dwordx4 v10, s[16:19], s34 offen offset:1024  lds
    buffer_load_dwordx4 v10, s[16:19], s34 offen offset:2048  lds
    buffer_load_dwordx4 v10, s[16:19], s34 offen offset:3072  lds
    s_add_u32 m0, m0, 4096
    s_sub_u32 s31, s31, 1
    buffer_load_dwordx4 v11, s[16:19], s34 offen  lds
    s_add_u32 m0, m0, 1024
    s_cmp_lg_u32 s31, 0
    s_cbranch_scc1 L_run_39
L_run_39_e:
    s_add_u32 s33, s62, 35
    s_mov_b32 m0, 61440
    s_mov_b32 s31, 2
    s_mul_i32 s33, s33, 5120
L_run_40:
    s_sub_u32 s34, s33, 245760
    s_cselect_b32 s33, s33, s34
    s_add_u32 s34, s33, s38
    s_add_u32 s33, s33, 5120
    buffer_load_dwordx4 v10, s[16:19], s34 offen offset:0  lds
    buffer_load_dwordx4 v10, s[16:19], s34 offen offset:1024  lds
    buffer_load_dwordx4 v10, s[16:19], s34 offen offset:2048  lds
    buffer_load_dwordx4 v10, s[16:19], s34 offen offset:3072  lds
    s_add_u32 m0, m0, 4096
    s_sub_u32 s31, s31, 1
    buffer_load_dwordx4 v11, s[16:19], s34 offen  lds
    s_add_u32 m0, m0, 1024
    s_cmp_lg_u32 s31, 0
    s_cbranch_scc1 L_run_40
L_run_40_e:
    s_barrier
    s_add_u32 s33, s62, 37
    s_mov_b32 m0, 0
    s_mov_b32 s31, 6
    s_mul_i32 s33, s33, 5120
L_run_41:
    s_sub_u32 s34, s33, 245760
    s_cselect_b32 s33, s33, s34
    s_add_u32 s34, s33, s38
    s_add_u32 s33, s33, 5120
    buffer_load_dwordx4 v10, s[16:19], s34 offen offset:0  lds
    buffer_load_dwordx4 v10, s[16:19], s34 offen offset:1024  lds
    buffer_load_dwordx4 v10, s[16:19], s34 offen offset:2048  lds
    buffer_load_dwordx4 v10, s[16:19], s34 offen offset:3072  lds
    s_add_u32 m0, m0, 4096
    s_sub_u32 s31, s31, 1
    buffer_load_dwordx4 v11, s[16:19], s34 offen  lds
    s_add_u32 m0, m0, 1024
    s_cmp_lg_u32 s31, 0
    s_cbranch_scc1 L_run_41
L_run_41_e:
    s_add_u32 s33, s62, 43
    s_mov_b32 m0, 143360
    s_mov_b32 s31, 3
    s_mul_i32 s33, s33, 5120
L_run_42:
    s_sub_u32 s34, s33, 245760
    s_cselect_b32 s33, s33, s34
    s_add_u32 s34, s33, s38
    s_add_u32 s33, s33, 5120
    buffer_load_dwordx4 v10, s[16:19], s34 offen offset:0  lds
    buffer_load_dwordx4 v10, s[16:19], s34 offen offset:1024  lds
    buffer_load_dwordx4 v10, s[16:19], s34 offen offset:2048  lds
    buffer_load_dwordx4 v10, s[16:19], s34 offen offset:3072  lds
    s_add_u32 m0, m0, 4096
    s_sub_u32 s31, s31, 1
    buffer_load_dwordx4 v11, s[16:19], s34 offen  lds
    s_add_u32 m0, m0, 1024
    s_cmp_lg_u32 s31, 0
    s_cbranch_scc1 L_run_42
L_run_42_e:
    s_add_u32 s33, s62, 46
    s_mov_b32 m0, 71680
    s_mov_b32 s31, 2
    s_mul_i32 s33, s33, 5120
L_run_43:
    s_sub_u32 s34, s33, 245760
    s_cselect_b32 s33, s33, s34
    s_add_u32 s34, s33, s38
    s_add_u32 s33, s33, 5120
    buffer_load_dwordx4 v10, s[16:19], s34 offen offset:0  lds
    buffer_load_dwordx4 v10, s[16:19], s34 offen offset:1024  lds
    buffer_load_dwordx4 v10, s[16:19], s34 offen offset:2048  lds
    buffer_load_dwordx4 v10, s[16:19], s34 offen offset:3072  lds
    s_add_u32 m0, m0, 4096
    s_sub_u32 s31, s31, 1
    buffer_load_dwordx4 v11, s[16:19], s34 offen  lds
    s_add_u32 m0, m0, 1024
    s_cmp_lg_u32 s31, 0
    s_cbranch_scc1 L_run_43
L_run_43_e:
    s_waitcnt vmcnt(55)
    s_barrier
    s_waitcnt vmcnt(30)
    s_barrier
    s_waitcnt vmcnt(0)
    s_cmp_ge_u32 s53, 1
    s_cbranch_scc1 L_kf_nowba
    buffer_wbl2 sc1
L_kf_nowba:
    s_barrier
    s_branch L_kf_fin
L_kf_compute:
    s_mul_i32 s31, s25, 81920
    s_add_u32 s31, s31, 5242880
    s_mul_i32 s32, s26, 1280
    s_xor_b32 s33, s26, 1
    s_mul_i32 s33, s33, 1280
    s_add_u32 s32, s32, s31
    s_add_u32 s33, s33, s31
    v_lshlrev_b32 v16, 4, v1
    v_lshlrev_b32 v17, 3, v2
    v_mov_b32 v8, 0
    v_mov_b32 v9, 0
    v_mov_b32 v14, 0
    v_mov_b32 v15, 0
    s_waitcnt lgkmcnt(0)
    s_mov_b32 s16, s44
    s_and_b32 s17, s45, 0xffff
    s_mov_b32 s18, 27262976
    s_mov_b32 s19, 0x20000
    s_mul_i32 s41, s35, 81920
    s_and_b32 s34, s24, 3
    s_lshl_b32 s34, s34, 12
    s_add_u32 m0, s34, s41
    s_mul_i32 s34, s25, 163840
    s_add_u32 s34, s34, m0
    buffer_load_dwordx4 v16, s[16:19], s34 offen offset:0  lds
    buffer_load_dwordx4 v16, s[16:19], s34 offen offset:1024  lds
    buffer_load_dwordx4 v16, s[16:19], s34 offen offset:2048  lds
    buffer_load_dwordx4 v16, s[16:19], s34 offen offset:3072  lds
    buffer_load_dwordx4 v[4:7], v16, s[16:19], s32 offen
    buffer_load_dwordx4 v[10:13], v16, s[16:19], s33 offen
    s_mov_b64 exec, 0xffffffff
    buffer_load_dwordx2 v[8:9], v17, s[16:19], s32 offen offset:1024
    buffer_load_dwordx2 v[14:15], v17, s[16:19], s33 offen offset:1024
    s_mov_b64 exec, -1
    v_add_u32 v17, 1024, v17
    v_lshlrev_b32 v18, 4, v3
    v_lshl_add_u32 v18, v2, 5, v18
    s_add_u32 s31, s41, 1280
    v_add_u32 v18, s31, v18
    s_mov_b32 s36, 0x000fffff
    s_mov_b32 s37, 0x000fffff
    v_cmp_eq_u32 vcc, 20, v2
    v_mov_b32 v22, 0x3f803f80
    v_mov_b32 v23, 0
    v_cndmask_b32 v31, v23, v22, vcc
    v_lshrrev_b32 v22, 4, v2
    s_lshl_b32 s32, s26, 1
    v_add_u32 v22, s32, v22
    v_mul_u32_u24 v22, 20480, v22
    v_and_b32 v23, 15, v1
    v_lshl_add_u32 v22, v23, 4, v22
    s_lshl_b32 s32, s25, 9
    v_lshl_add_u32 v24, v3, 8, v22
    v_add_u32 v24, s32, v24
    s_lshl_b32 s32, s25, 7
    s_add_u32 s32, s32, 16384
    v_lshlrev_b32 v23, 3, v23
    v_sub_u32 v25, v22, v23
    v_add_u32 v25, s32, v25
    s_mov_b32 s28, 0
    s_mov_b32 s29, 1
    s_mov_b32 s30, 0
    v_mov_b32 v144, v31
    v_mov_b32 v145, v31
    v_mov_b32 v146, v31
    v_mov_b32 v147, v31
    v_mov_b32 v148, v31
    v_mov_b32 v149, v31
    v_mov_b32 v150, v31
    v_mov_b32 v151, v31
    v_mov_b32 v96, 0
    v_mov_b32 v97, 0
    v_mov_b32 v98, 0
    v_mov_b32 v99, 0
    v_mov_b32 v100, 0
    v_mov_b32 v101, 0
    v_mov_b32 v102, 0
    v_mov_b32 v103, 0
    v_mov_b32 v104, 0
    v_mov_b32 v105, 0
    v_mov_b32 v106, 0
    v_mov_b32 v107, 0
    v_mov_b32 v108, 0
    v_mov_b32 v109, 0
    v_mov_b32 v110, 0
    v_mov_b32 v111, 0
    v_mov_b32 v112, 0
    v_mov_b32 v113, 0
    v_mov_b32 v114, 0
    v_mov_b32 v115, 0
    v_mov_b32 v116, 0
    v_mov_b32 v117, 0
    v_mov_b32 v118, 0
    v_mov_b32 v119, 0
    v_mov_b32 v120, 0
    v_mov_b32 v121, 0
    v_mov_b32 v122, 0
    v_mov_b32 v123, 0
    v_mov_b32 v124, 0
    v_mov_b32 v125, 0
    v_mov_b32 v126, 0
    v_mov_b32 v127, 0
    v_mov_b32 v132, 0
    v_mov_b32 v133, 0
    v_mov_b32 v134, 0
    v_mov_b32 v135, 0
    s_mov_b32 s8, s6
    s_and_b32 s9, s7, 0xffff
    s_mov_b32 s10, 2621440
    s_mov_b32 s11, 0x20000
    s_lshl_b32 s56, s52, 2
    s_and_b32 s31, s53, 3
    s_add_u32 s56, s56, s31
    s_lshl_b32 s56, s56, 2
    s_add_u32 s56, s56, s24
    s_mul_i32 s31, s56, 20480
    s_mul_i32 s33, s57, 160
    s_add_u32 s33, s33, s31
    v_and_b32 v22, 15, v1
    v_mul_u32_u24 v22, 1280, v22
    v_lshrrev_b32 v23, 4, v1
    v_mul_u32_u24 v23, 40, v23
    v_add3_u32 v162, v22, v23, s33
L_kf_nox:
    s_waitcnt vmcnt(0)
    s_barrier
    ds_read_b128 v[136:139], v16
    ds_read_b64 v[140:141], v17
    v_add_u32 v16, s41, v16
    v_add_u32 v17, s41, v17
    s_waitcnt lgkmcnt(0)
    v_mfma_f32_32x32x16_bf16 v[64:79], v[136:139], v[4:7], 0
    v_mfma_f32_32x32x8_bf16 v[64:79], v[140:141], v[8:9], v[64:79]
    v_mfma_f32_32x32x16_bf16 v[80:95], v[136:139], v[10:13], 0
    v_mfma_f32_32x32x8_bf16 v[80:95], v[140:141], v[14:15], v[80:95]
    s_nop 9
    v_max3_f32 v19, v64, v65, v66
    v_max3_f32 v19, v19, v67, v68
    v_max3_f32 v19, v19, v69, v70
    v_max3_f32 v19, v19, v71, v72
    v_max3_f32 v19, v19, v73, v74
    v_max3_f32 v19, v19, v75, v76
    v_max3_f32 v19, v19, v77, v78
    v_max_f32 v19, v19, v79
    v_max3_f32 v20, v80, v81, v82
    v_max3_f32 v20, v20, v83, v84
    v_max3_f32 v20, v20, v85, v86
    v_max3_f32 v20, v20, v87, v88
    v_max3_f32 v20, v20, v89, v90
    v_max3_f32 v20, v20, v91, v92
    v_max3_f32 v20, v20, v93, v94
    v_max_f32 v20, v20, v95
    ds_read_b128 v[136:139], v16
    ds_read2st64_b64 v[140:143], v17 offset0:0 offset1:5
    s_mov_b64 exec, s[36:37]
    ds_read_b128 v[144:147], v18
    s_mov_b64 exec, -1
    v_mov_b32 v22, v19
    v_mov_b32 v23, v20
    s_nop 1
    v_permlane32_swap_b32 v19, v22
    v_permlane32_swap_b32 v20, v23
    s_nop 1
    v_max_f32 v19, v19, v22
    v_max_f32 v20, v20, v23
    v_sub_f32 v32, 0, v19
    v_sub_f32 v33, 0, v19
    v_sub_f32 v34, 0, v19
    v_sub_f32 v35, 0, v19
    v_sub_f32 v36, 0, v19
    v_sub_f32 v37, 0, v19
    v_sub_f32 v38, 0, v19
    v_sub_f32 v39, 0, v19
    v_sub_f32 v40, 0, v19
    v_sub_f32 v41, 0, v19
    v_sub_f32 v42, 0, v19
    v_sub_f32 v43, 0, v19
    v_sub_f32 v44, 0, v19
    v_sub_f32 v45, 0, v19
    v_sub_f32 v46, 0, v19
    v_sub_f32 v47, 0, v19
    s_waitcnt lgkmcnt(0)
    s_mov_b32 s27, 0
    s_nop 0
    v_mfma_f32_32x32x16_bf16 v[64:79], v[136:139], v[4:7], v[32:47]
    v_mfma_f32_32x32x8_bf16 v[64:79], v[140:141], v[8:9], v[64:79]
    v_sub_f32 v48, 0, v20
    v_sub_f32 v49, 0, v20
    v_sub_f32 v50, 0, v20
    v_sub_f32 v51, 0, v20
    v_sub_f32 v52, 0, v20
    v_sub_f32 v53, 0, v20
    v_sub_f32 v54, 0, v20
    v_sub_f32 v55, 0, v20
    v_sub_f32 v56, 0, v20
    v_sub_f32 v57, 0, v20
    v_sub_f32 v58, 0, v20
    v_sub_f32 v59, 0, v20
    v_sub_f32 v60, 0, v20
    v_sub_f32 v61, 0, v20
    v_sub_f32 v62, 0, v20
    v_sub_f32 v63, 0, v20
    s_setprio 2
.p2align 3
L_kf_loop:
    s_bitcmp1_b32 12, s27
    s_cbranch_scc1 L_kfs_44
L_kfs_44_r:
    v_mfma_f32_32x32x16_bf16 v[80:95], v[136:139], v[10:13], v[48:63]
    ds_read_b128 v[136:139], v16 offset:2560
    v_exp_f32 v64, v64
    v_exp_f32 v65, v65
    v_exp_f32 v66, v66
    v_exp_f32 v67, v67
    v_mfma_f32_32x32x16_bf16 v[112:127], v[148:151], v[132:135], v[112:127]
    s_mov_b64 exec, s[36:37]
    ds_read_b128 v[148:151], v18 offset:640
    s_mov_b64 exec, -1
    v_exp_f32 v68, v68
    v_exp_f32 v69, v69
    v_exp_f32 v70, v70
    v_exp_f32 v71, v71
    v_mfma_f32_32x32x8_bf16 v[80:95], v[140:141], v[14:15], v[80:95]
    v_cvt_pk_bf16_f32 v128, v64, v65
    v_cvt_pk_bf16_f32 v129, v66, v67
    v_cvt_pk_bf16_f32 v130, v68, v69
    v_cvt_pk_bf16_f32 v131, v70, v71
    v_exp_f32 v72, v72
    v_exp_f32 v73, v73
    v_exp_f32 v74, v74
    s_waitcnt lgkmcnt(2)
    v_mfma_f32_32x32x16_bf16 v[96:111], v[144:147], v[128:131], v[96:111]
    v_exp_f32 v75, v75
    v_exp_f32 v76, v76
    v_exp_f32 v77, v77
    v_exp_f32 v78, v78
    v_exp_f32 v79, v79
    v_cvt_pk_bf16_f32 v132, v72, v73
    v_cvt_pk_bf16_f32 v133, v74, v75
    v_cvt_pk_bf16_f32 v134, v76, v77
    v_cvt_pk_bf16_f32 v135, v78, v79
    s_waitcnt lgkmcnt(0)
    v_mfma_f32_32x32x16_bf16 v[64:79], v[136:139], v[4:7], v[32:47]
    v_exp_f32 v80, v80
    v_exp_f32 v81, v81
    v_exp_f32 v82, v82
    v_exp_f32 v83, v83
    v_mfma_f32_32x32x16_bf16 v[96:111], v[148:151], v[132:135], v[96:111]
    v_exp_f32 v84, v84
    v_exp_f32 v85, v85
    v_exp_f32 v86, v86
    v_exp_f32 v87, v87
    v_mfma_f32_32x32x8_bf16 v[64:79], v[142:143], v[8:9], v[64:79]
    v_cvt_pk_bf16_f32 v128, v80, v81
    v_cvt_pk_bf16_f32 v129, v82, v83
    v_cvt_pk_bf16_f32 v130, v84, v85
    v_cvt_pk_bf16_f32 v131, v86, v87
    v_exp_f32 v88, v88
    v_exp_f32 v89, v89
    v_exp_f32 v90, v90
    v_mfma_f32_32x32x16_bf16 v[112:127], v[144:147], v[128:131], v[112:127]
    s_mov_b64 exec, s[36:37]
    ds_read_b128 v[144:147], v18 offset:2560
    s_mov_b64 exec, -1
    v_exp_f32 v91, v91
    v_exp_f32 v92, v92
    v_exp_f32 v93, v93
    v_exp_f32 v94, v94
    v_exp_f32 v95, v95
    v_cvt_pk_bf16_f32 v132, v88, v89
    v_cvt_pk_bf16_f32 v133, v90, v91
    v_cvt_pk_bf16_f32 v134, v92, v93
    v_cvt_pk_bf16_f32 v135, v94, v95
    v_mfma_f32_32x32x16_bf16 v[80:95], v[136:139], v[10:13], v[48:63]
    ds_read_b128 v[136:139], v16 offset:5120
    v_exp_f32 v64, v64
    v_exp_f32 v65, v65
    v_exp_f32 v66, v66
    v_exp_f32 v67, v67
    v_mfma_f32_32x32x16_bf16 v[112:127], v[148:151], v[132:135], v[112:127]
    s_mov_b64 exec, s[36:37]
    ds_read_b128 v[148:151], v18 offset:3200
    s_mov_b64 exec, -1
    v_exp_f32 v68, v68
    v_exp_f32 v69, v69
    v_exp_f32 v70, v70
    v_exp_f32 v71, v71
    v_mfma_f32_32x32x8_bf16 v[80:95], v[142:143], v[14:15], v[80:95]
    ds_read2st64_b64 v[140:143], v17 offset0:10 offset1:15
    v_cvt_pk_bf16_f32 v128, v64, v65
    v_cvt_pk_bf16_f32 v129, v66, v67
    v_cvt_pk_bf16_f32 v130, v68, v69
    v_cvt_pk_bf16_f32 v131, v70, v71
    v_exp_f32 v72, v72
    v_exp_f32 v73, v73
    v_exp_f32 v74, v74
    s_waitcnt lgkmcnt(3)
    v_mfma_f32_32x32x16_bf16 v[96:111], v[144:147], v[128:131], v[96:111]
    v_exp_f32 v75, v75
    v_exp_f32 v76, v76
    v_exp_f32 v77, v77
    v_exp_f32 v78, v78
    v_exp_f32 v79, v79
    v_cvt_pk_bf16_f32 v132, v72, v73
    v_cvt_pk_bf16_f32 v133, v74, v75
    v_cvt_pk_bf16_f32 v134, v76, v77
    v_cvt_pk_bf16_f32 v135, v78, v79
    s_waitcnt lgkmcnt(0)
    v_mfma_f32_32x32x16_bf16 v[64:79], v[136:139], v[4:7], v[32:47]
    v_exp_f32 v80, v80
    v_exp_f32 v81, v81
    v_exp_f32 v82, v82
    v_exp_f32 v83, v83
    v_mfma_f32_32x32x16_bf16 v[96:111], v[148:151], v[132:135], v[96:111]
    v_exp_f32 v84, v84
    v_exp_f32 v85, v85
    v_exp_f32 v86, v86
    v_exp_f32 v87, v87
    v_mfma_f32_32x32x8_bf16 v[64:79], v[140:141], v[8:9], v[64:79]
    v_cvt_pk_bf16_f32 v128, v80, v81
    v_cvt_pk_bf16_f32 v129, v82, v83
    v_cvt_pk_bf16_f32 v130, v84, v85
    v_cvt_pk_bf16_f32 v131, v86, v87
    v_exp_f32 v88, v88
    v_exp_f32 v89, v89
    v_exp_f32 v90, v90
    v_mfma_f32_32x32x16_bf16 v[112:127], v[144:147], v[128:131], v[112:127]
    s_mov_b64 exec, s[36:37]
    ds_read_b128 v[144:147], v18 offset:5120
    s_mov_b64 exec, -1
    v_exp_f32 v91, v91
    v_exp_f32 v92, v92
    v_exp_f32 v93, v93
    v_exp_f32 v94, v94
    v_exp_f32 v95, v95
    v_cvt_pk_bf16_f32 v132, v88, v89
    v_cvt_pk_bf16_f32 v133, v90, v91
    v_cvt_pk_bf16_f32 v134, v92, v93
    v_cvt_pk_bf16_f32 v135, v94, v95
    v_mfma_f32_32x32x16_bf16 v[80:95], v[136:139], v[10:13], v[48:63]
    ds_read_b128 v[136:139], v16 offset:7680
    v_exp_f32 v64, v64
    v_exp_f32 v65, v65
    v_exp_f32 v66, v66
    v_exp_f32 v67, v67
    v_mfma_f32_32x32x16_bf16 v[112:127], v[148:151], v[132:135], v[112:127]
    s_mov_b64 exec, s[36:37]
    ds_read_b128 v[148:151], v18 offset:5760
    s_mov_b64 exec, -1
    v_exp_f32 v68, v68
    v_exp_f32 v69, v69
    v_exp_f32 v70, v70
    v_exp_f32 v71, v71
    v_mfma_f32_32x32x8_bf16 v[80:95], v[140:141], v[14:15], v[80:95]
    v_cvt_pk_bf16_f32 v128, v64, v65
    v_cvt_pk_bf16_f32 v129, v66, v67
    v_cvt_pk_bf16_f32 v130, v68, v69
    v_cvt_pk_bf16_f32 v131, v70, v71
    v_exp_f32 v72, v72
    v_exp_f32 v73, v73
    v_exp_f32 v74, v74
    s_waitcnt lgkmcnt(2)
    v_mfma_f32_32x32x16_bf16 v[96:111], v[144:147], v[128:131], v[96:111]
    v_exp_f32 v75, v75
    v_exp_f32 v76, v76
    v_exp_f32 v77, v77
    v_exp_f32 v78, v78
    v_exp_f32 v79, v79
    v_cvt_pk_bf16_f32 v132, v72, v73
    v_cvt_pk_bf16_f32 v133, v74, v75
    v_cvt_pk_bf16_f32 v134, v76, v77
    v_cvt_pk_bf16_f32 v135, v78, v79
    s_waitcnt lgkmcnt(0)
    v_mfma_f32_32x32x16_bf16 v[64:79], v[136:139], v[4:7], v[32:47]
    v_exp_f32 v80, v80
    v_exp_f32 v81, v81
    v_exp_f32 v82, v82
    v_exp_f32 v83, v83
    v_mfma_f32_32x32x16_bf16 v[96:111], v[148:151], v[132:135], v[96:111]
    v_exp_f32 v84, v84
    v_exp_f32 v85, v85
    v_exp_f32 v86, v86
    v_exp_f32 v87, v87
    v_mfma_f32_32x32x8_bf16 v[64:79], v[142:143], v[8:9], v[64:79]
    v_cvt_pk_bf16_f32 v128, v80, v81
    v_cvt_pk_bf16_f32 v129, v82, v83
    v_cvt_pk_bf16_f32 v130, v84, v85
    v_cvt_pk_bf16_f32 v131, v86, v87
    v_exp_f32 v88, v88
    v_exp_f32 v89, v89
    v_exp_f32 v90, v90
    v_mfma_f32_32x32x16_bf16 v[112:127], v[144:147], v[128:131], v[112:127]
    s_mov_b64 exec, s[36:37]
    ds_read_b128 v[144:147], v18 offset:7680
    s_mov_b64 exec, -1
    v_exp_f32 v91, v91
    v_exp_f32 v92, v92
    v_exp_f32 v93, v93
    v_exp_f32 v94, v94
    v_exp_f32 v95, v95
    v_cvt_pk_bf16_f32 v132, v88, v89
    v_cvt_pk_bf16_f32 v133, v90, v91
    v_cvt_pk_bf16_f32 v134, v92, v93
    v_cvt_pk_bf16_f32 v135, v94, v95
    s_bitcmp1_b32 1, s27
    s_cbranch_scc1 L_kfs_45
L_kfs_45_r:
    v_mfma_f32_32x32x16_bf16 v[80:95], v[136:139], v[10:13], v[48:63]
    ds_read_b128 v[136:139], v16 offset:10240
    v_exp_f32 v64, v64
    v_exp_f32 v65, v65
    v_exp_f32 v66, v66
    v_exp_f32 v67, v67
    v_mfma_f32_32x32x16_bf16 v[112:127], v[148:151], v[132:135], v[112:127]
    s_mov_b64 exec, s[36:37]
    ds_read_b128 v[148:151], v18 offset:8320
    s_mov_b64 exec, -1
    v_exp_f32 v68, v68
    v_exp_f32 v69, v69
    v_exp_f32 v70, v70
    v_exp_f32 v71, v71
    v_mfma_f32_32x32x8_bf16 v[80:95], v[142:143], v[14:15], v[80:95]
    ds_read2st64_b64 v[140:143], v17 offset0:20 offset1:25
    v_cvt_pk_bf16_f32 v128, v64, v65
    v_cvt_pk_bf16_f32 v129, v66, v67
    v_cvt_pk_bf16_f32 v130, v68, v69
    v_cvt_pk_bf16_f32 v131, v70, v71
    v_exp_f32 v72, v72
    v_exp_f32 v73, v73
    v_exp_f32 v74, v74
    s_waitcnt lgkmcnt(3)
    v_mfma_f32_32x32x16_bf16 v[96:111], v[144:147], v[128:131], v[96:111]
    v_exp_f32 v75, v75
    v_exp_f32 v76, v76
    v_exp_f32 v77, v77
    v_exp_f32 v78, v78
    v_exp_f32 v79, v79
    v_cvt_pk_bf16_f32 v132, v72, v73
    v_cvt_pk_bf16_f32 v133, v74, v75
    v_cvt_pk_bf16_f32 v134, v76, v77
    v_cvt_pk_bf16_f32 v135, v78, v79
    s_waitcnt lgkmcnt(0)
    v_mfma_f32_32x32x16_bf16 v[64:79], v[136:139], v[4:7], v[32:47]
    v_exp_f32 v80, v80
    v_exp_f32 v81, v81
    v_exp_f32 v82, v82
    v_exp_f32 v83, v83
    v_mfma_f32_32x32x16_bf16 v[96:111], v[148:151], v[132:135], v[96:111]
    v_exp_f32 v84, v84
    v_exp_f32 v85, v85
    v_exp_f32 v86, v86
    v_exp_f32 v87, v87
    v_mfma_f32_32x32x8_bf16 v[64:79], v[140:141], v[8:9], v[64:79]
    v_cvt_pk_bf16_f32 v128, v80, v81
    v_cvt_pk_bf16_f32 v129, v82, v83
    v_cvt_pk_bf16_f32 v130, v84, v85
    v_cvt_pk_bf16_f32 v131, v86, v87
    v_exp_f32 v88, v88
    v_exp_f32 v89, v89
    v_exp_f32 v90, v90
    v_mfma_f32_32x32x16_bf16 v[112:127], v[144:147], v[128:131], v[112:127]
    s_mov_b64 exec, s[36:37]
    ds_read_b128 v[144:147], v18 offset:10240
    s_mov_b64 exec, -1
    v_exp_f32 v91, v91
    v_exp_f32 v92, v92
    v_exp_f32 v93, v93
    v_exp_f32 v94, v94
    v_exp_f32 v95, v95
    v_cvt_pk_bf16_f32 v132, v88, v89
    v_cvt_pk_bf16_f32 v133, v90, v91
    v_cvt_pk_bf16_f32 v134, v92, v93
    v_cvt_pk_bf16_f32 v135, v94, v95
    s_bitcmp1_b32 1, s27
    s_cbranch_scc1 L_kfs_46
L_kfs_46_r:
    v_mfma_f32_32x32x16_bf16 v[80:95], v[136:139], v[10:13], v[48:63]
    ds_read_b128 v[136:139], v16 offset:12800
    v_exp_f32 v64, v64
    v_exp_f32 v65, v65
    v_exp_f32 v66, v66
    v_exp_f32 v67, v67
    v_mfma_f32_32x32x16_bf16 v[112:127], v[148:151], v[132:135], v[112:127]
    s_mov_b64 exec, s[36:37]
    ds_read_b128 v[148:151], v18 offset:10880
    s_mov_b64 exec, -1
    v_exp_f32 v68, v68
    v_exp_f32 v69, v69
    v_exp_f32 v70, v70
    v_exp_f32 v71, v71
    v_mfma_f32_32x32x8_bf16 v[80:95], v[140:141], v[14:15], v[80:95]
    v_cvt_pk_bf16_f32 v128, v64, v65
    v_cvt_pk_bf16_f32 v129, v66, v67
    v_cvt_pk_bf16_f32 v130, v68, v69
    v_cvt_pk_bf16_f32 v131, v70, v71
    v_exp_f32 v72, v72
    v_exp_f32 v73, v73
    v_exp_f32 v74, v74
    s_waitcnt lgkmcnt(2)
    v_mfma_f32_32x32x16_bf16 v[96:111], v[144:147], v[128:131], v[96:111]
    v_exp_f32 v75, v75
    v_exp_f32 v76, v76
    v_exp_f32 v77, v77
    v_exp_f32 v78, v78
    v_exp_f32 v79, v79
    v_cvt_pk_bf16_f32 v132, v72, v73
    v_cvt_pk_bf16_f32 v133, v74, v75
    v_cvt_pk_bf16_f32 v134, v76, v77
    v_cvt_pk_bf16_f32 v135, v78, v79
    s_waitcnt lgkmcnt(0)
    v_mfma_f32_32x32x16_bf16 v[64:79], v[136:139], v[4:7], v[32:47]
    v_exp_f32 v80, v80
    v_exp_f32 v81, v81
    v_exp_f32 v82, v82
    v_exp_f32 v83, v83
    v_mfma_f32_32x32x16_bf16 v[96:111], v[148:151], v[132:135], v[96:111]
    v_exp_f32 v84, v84
    v_exp_f32 v85, v85
    v_exp_f32 v86, v86
    v_exp_f32 v87, v87
    v_mfma_f32_32x32x8_bf16 v[64:79], v[142:143], v[8:9], v[64:79]
    v_cvt_pk_bf16_f32 v128, v80, v81
    v_cvt_pk_bf16_f32 v129, v82, v83
    v_cvt_pk_bf16_f32 v130, v84, v85
    v_cvt_pk_bf16_f32 v131, v86, v87
    v_exp_f32 v88, v88
    v_exp_f32 v89, v89
    v_exp_f32 v90, v90
    v_mfma_f32_32x32x16_bf16 v[112:127], v[144:147], v[128:131], v[112:127]
    s_mov_b64 exec, s[36:37]
    ds_read_b128 v[144:147], v18 offset:12800
    s_mov_b64 exec, -1
    v_exp_f32 v91, v91
    v_exp_f32 v92, v92
    v_exp_f32 v93, v93
    v_exp_f32 v94, v94
    v_exp_f32 v95, v95
    v_cvt_pk_bf16_f32 v132, v88, v89
    v_cvt_pk_bf16_f32 v133, v90, v91
    v_cvt_pk_bf16_f32 v134, v92, v93
    v_cvt_pk_bf16_f32 v135, v94, v95
    s_bitcmp1_b32 8, s27
    s_cbranch_scc1 L_kfs_47
L_kfs_47_r:
    v_mfma_f32_32x32x16_bf16 v[80:95], v[136:139], v[10:13], v[48:63]
    ds_read_b128 v[136:139], v16 offset:15360
    v_exp_f32 v64, v64
    v_exp_f32 v65, v65
    v_exp_f32 v66, v66
    v_exp_f32 v67, v67
    v_mfma_f32_32x32x16_bf16 v[112:127], v[148:151], v[132:135], v[112:127]
    s_mov_b64 exec, s[36:37]
    ds_read_b128 v[148:151], v18 offset:13440
    s_mov_b64 exec, -1
    v_exp_f32 v68, v68
    v_exp_f32 v69, v69
    v_exp_f32 v70, v70
    v_exp_f32 v71, v71
    v_mfma_f32_32x32x8_bf16 v[80:95], v[142:143], v[14:15], v[80:95]
    ds_read2st64_b64 v[140:143], v17 offset0:30 offset1:35
    v_cvt_pk_bf16_f32 v128, v64, v65
    v_cvt_pk_bf16_f32 v129, v66, v67
    v_cvt_pk_bf16_f32 v130, v68, v69
    v_cvt_pk_bf16_f32 v131, v70, v71
    v_exp_f32 v72, v72
    v_exp_f32 v73, v73
    v_exp_f32 v74, v74
    s_waitcnt lgkmcnt(3)
    v_mfma_f32_32x32x16_bf16 v[96:111], v[144:147], v[128:131], v[96:111]
    v_exp_f32 v75, v75
    v_exp_f32 v76, v76
    v_exp_f32 v77, v77
    v_exp_f32 v78, v78
    v_exp_f32 v79, v79
    v_cvt_pk_bf16_f32 v132, v72, v73
    v_cvt_pk_bf16_f32 v133, v74, v75
    v_cvt_pk_bf16_f32 v134, v76, v77
    v_cvt_pk_bf16_f32 v135, v78, v79
    s_waitcnt lgkmcnt(0)
    v_mfma_f32_32x32x16_bf16 v[64:79], v[136:139], v[4:7], v[32:47]
    v_exp_f32 v80, v80
    v_exp_f32 v81, v81
    v_exp_f32 v82, v82
    v_exp_f32 v83, v83
    v_mfma_f32_32x32x16_bf16 v[96:111], v[148:151], v[132:135], v[96:111]
    v_exp_f32 v84, v84
    v_exp_f32 v85, v85
    v_exp_f32 v86, v86
    v_exp_f32 v87, v87
    v_mfma_f32_32x32x8_bf16 v[64:79], v[140:141], v[8:9], v[64:79]
    v_cvt_pk_bf16_f32 v128, v80, v81
    v_cvt_pk_bf16_f32 v129, v82, v83
    v_cvt_pk_bf16_f32 v130, v84, v85
    v_cvt_pk_bf16_f32 v131, v86, v87
    v_exp_f32 v88, v88
    v_exp_f32 v89, v89
    v_exp_f32 v90, v90
    v_mfma_f32_32x32x16_bf16 v[112:127], v[144:147], v[128:131], v[112:127]
    s_mov_b64 exec, s[36:37]
    ds_read_b128 v[144:147], v18 offset:15360
    s_mov_b64 exec, -1
    v_exp_f32 v91, v91
    v_exp_f32 v92, v92
    v_exp_f32 v93, v93
    v_exp_f32 v94, v94
    v_exp_f32 v95, v95
    v_cvt_pk_bf16_f32 v132, v88, v89
    v_cvt_pk_bf16_f32 v133, v90, v91
    v_cvt_pk_bf16_f32 v134, v92, v93
    v_cvt_pk_bf16_f32 v135, v94, v95
    s_bitcmp1_b32 4, s27
    s_cbranch_scc1 L_kfs_48
L_kfs_48_r:
    v_mfma_f32_32x32x16_bf16 v[80:95], v[136:139], v[10:13], v[48:63]
    ds_read_b128 v[136:139], v16 offset:17920
    v_exp_f32 v64, v64
    v_exp_f32 v65, v65
    v_exp_f32 v66, v66
    v_exp_f32 v67, v67
    v_mfma_f32_32x32x16_bf16 v[112:127], v[148:151], v[132:135], v[112:127]
    s_mov_b64 exec, s[36:37]
    ds_read_b128 v[148:151], v18 offset:16000
    s_mov_b64 exec, -1
    v_exp_f32 v68, v68
    v_exp_f32 v69, v69
    v_exp_f32 v70, v70
    v_exp_f32 v71, v71
    v_mfma_f32_32x32x8_bf16 v[80:95], v[140:141], v[14:15], v[80:95]
    v_cvt_pk_bf16_f32 v128, v64, v65
    v_cvt_pk_bf16_f32 v129, v66, v67
    v_cvt_pk_bf16_f32 v130, v68, v69
    v_cvt_pk_bf16_f32 v131, v70, v71
    v_exp_f32 v72, v72
    v_exp_f32 v73, v73
    v_exp_f32 v74, v74
    s_waitcnt lgkmcnt(2)
    v_mfma_f32_32x32x16_bf16 v[96:111], v[144:147], v[128:131], v[96:111]
    v_exp_f32 v75, v75
    v_exp_f32 v76, v76
    v_exp_f32 v77, v77
    v_exp_f32 v78, v78
    v_exp_f32 v79, v79
    v_cvt_pk_bf16_f32 v132, v72, v73
    v_cvt_pk_bf16_f32 v133, v74, v75
    v_cvt_pk_bf16_f32 v134, v76, v77
    v_cvt_pk_bf16_f32 v135, v78, v79
    s_waitcnt lgkmcnt(0)
    v_mfma_f32_32x32x16_bf16 v[64:79], v[136:139], v[4:7], v[32:47]
    v_exp_f32 v80, v80
    v_exp_f32 v81, v81
    v_exp_f32 v82, v82
    v_exp_f32 v83, v83
    v_mfma_f32_32x32x16_bf16 v[96:111], v[148:151], v[132:135], v[96:111]
    v_exp_f32 v84, v84
    v_exp_f32 v85, v85
    v_exp_f32 v86, v86
    v_exp_f32 v87, v87
    v_mfma_f32_32x32x8_bf16 v[64:79], v[142:143], v[8:9], v[64:79]
    v_cvt_pk_bf16_f32 v128, v80, v81
    v_cvt_pk_bf16_f32 v129, v82, v83
    v_cvt_pk_bf16_f32 v130, v84, v85
    v_cvt_pk_bf16_f32 v131, v86, v87
    v_exp_f32 v88, v88
    v_exp_f32 v89, v89
    v_exp_f32 v90, v90
    v_mfma_f32_32x32x16_bf16 v[112:127], v[144:147], v[128:131], v[112:127]
    s_mov_b64 exec, s[36:37]
    ds_read_b128 v[144:147], v18 offset:17920
    s_mov_b64 exec, -1
    v_exp_f32 v91, v91
    v_exp_f32 v92, v92
    v_exp_f32 v93, v93
    v_exp_f32 v94, v94
    v_exp_f32 v95, v95
    v_cvt_pk_bf16_f32 v132, v88, v89
    v_cvt_pk_bf16_f32 v133, v90, v91
    v_cvt_pk_bf16_f32 v134, v92, v93
    v_cvt_pk_bf16_f32 v135, v94, v95
    s_bitcmp1_b32 8, s27
    s_cbranch_scc1 L_kfs_49
L_kfs_49_r:
    v_mfma_f32_32x32x16_bf16 v[80:95], v[136:139], v[10:13], v[48:63]
    ds_read_b128 v[136:139], v16 offset:20480
    v_exp_f32 v64, v64
    v_exp_f32 v65, v65
    v_exp_f32 v66, v66
    v_exp_f32 v67, v67
    v_mfma_f32_32x32x16_bf16 v[112:127], v[148:151], v[132:135], v[112:127]
    s_mov_b64 exec, s[36:37]
    ds_read_b128 v[148:151], v18 offset:18560
    s_mov_b64 exec, -1
    v_exp_f32 v68, v68
    v_exp_f32 v69, v69
    v_exp_f32 v70, v70
    v_exp_f32 v71, v71
    v_mfma_f32_32x32x8_bf16 v[80:95], v[142:143], v[14:15], v[80:95]
    ds_read2st64_b64 v[140:143], v17 offset0:40 offset1:45
    v_cvt_pk_bf16_f32 v128, v64, v65
    v_cvt_pk_bf16_f32 v129, v66, v67
    v_cvt_pk_bf16_f32 v130, v68, v69
    v_cvt_pk_bf16_f32 v131, v70, v71
    v_exp_f32 v72, v72
    v_exp_f32 v73, v73
    v_exp_f32 v74, v74
    s_waitcnt lgkmcnt(3)
    v_mfma_f32_32x32x16_bf16 v[96:111], v[144:147], v[128:131], v[96:111]
    v_exp_f32 v75, v75
    v_exp_f32 v76, v76
    v_exp_f32 v77, v77
    v_exp_f32 v78, v78
    v_exp_f32 v79, v79
    v_cvt_pk_bf16_f32 v132, v72, v73
    v_cvt_pk_bf16_f32 v133, v74, v75
    v_cvt_pk_bf16_f32 v134, v76, v77
    v_cvt_pk_bf16_f32 v135, v78, v79
    s_waitcnt lgkmcnt(0)
    v_mfma_f32_32x32x16_bf16 v[64:79], v[136:139], v[4:7], v[32:47]
    v_exp_f32 v80, v80
    v_exp_f32 v81, v81
    v_exp_f32 v82, v82
    v_exp_f32 v83, v83
    v_mfma_f32_32x32x16_bf16 v[96:111], v[148:151], v[132:135], v[96:111]
    v_exp_f32 v84, v84
    v_exp_f32 v85, v85
    v_exp_f32 v86, v86
    v_exp_f32 v87, v87
    v_mfma_f32_32x32x8_bf16 v[64:79], v[140:141], v[8:9], v[64:79]
    v_cvt_pk_bf16_f32 v128, v80, v81
    v_cvt_pk_bf16_f32 v129, v82, v83
    v_cvt_pk_bf16_f32 v130, v84, v85
    v_cvt_pk_bf16_f32 v131, v86, v87
    v_exp_f32 v88, v88
    v_exp_f32 v89, v89
    v_exp_f32 v90, v90
    v_mfma_f32_32x32x16_bf16 v[112:127], v[144:147], v[128:131], v[112:127]
    s_mov_b64 exec, s[36:37]
    ds_read_b128 v[144:147], v18 offset:20480
    s_mov_b64 exec, -1
    v_exp_f32 v91, v91
    v_exp_f32 v92, v92
    v_exp_f32 v93, v93
    v_exp_f32 v94, v94
    v_exp_f32 v95, v95
    s_add_u32 s27, s27, 1
    s_cmp_lt_u32 s27, 4
    v_cvt_pk_bf16_f32 v132, v88, v89
    v_cvt_pk_bf16_f32 v133, v90, v91
    v_cvt_pk_bf16_f32 v134, v92, v93
    v_cvt_pk_bf16_f32 v135, v94, v95
    v_add_u32 v16, 20480, v16
    v_add_u32 v17, 20480, v17
    v_add_u32 v18, 20480, v18
    s_cbranch_scc1 L_kf_loop
    v_mfma_f32_32x32x16_bf16 v[112:127], v[148:151], v[132:135], v[112:127]
    v_subrev_u32 v16, 81920, v16
    v_subrev_u32 v17, 81920, v17
    v_subrev_u32 v18, 81920, v18
    v_add_f32 v28, abs(v96), abs(v97)
    v_add_f32 v28, v28, abs(v98)
    v_add_f32 v28, v28, abs(v99)
    v_add_f32 v28, v28, abs(v100)
    v_add_f32 v28, v28, abs(v101)
    v_add_f32 v28, v28, abs(v102)
    v_add_f32 v28, v28, abs(v103)
    v_add_f32 v28, v28, abs(v104)
    s_waitcnt lgkmcnt(0)
    v_add_f32 v28, v28, abs(v105)
    v_add_f32 v28, v28, abs(v106)
    v_add_f32 v28, v28, abs(v107)
    v_add_f32 v28, v28, abs(v112)
    v_add_f32 v28, v28, abs(v113)
    v_add_f32 v28, v28, abs(v114)
    v_add_f32 v28, v28, abs(v115)
    v_add_f32 v28, v28, abs(v116)
    v_add_f32 v28, v28, abs(v117)
    v_add_f32 v28, v28, abs(v118)
    v_add_f32 v28, v28, abs(v119)
    v_add_f32 v28, v28, abs(v120)
    v_add_f32 v28, v28, abs(v121)
    v_add_f32 v28, v28, abs(v122)
    v_add_f32 v28, v28, abs(v123)
    s_mov_b32 s31, 0x7e000000
    v_cmp_ngt_f32 vcc, s31, v28
    s_nop 2
    s_cbranch_vccnz L_kf_fallback
L_kf_store:
    s_mul_i32 s31, s24, 3328
    s_xor_b32 s32, s24, 4
    s_mul_i32 s32, s32, 3328
    v_lshl_add_u32 v22, v1, 4, s31
    v_lshl_add_u32 v23, v1, 2, s31
    ds_write_b128 v22, v[112:115] offset:0
    ds_write_b128 v22, v[116:119] offset:1024
    ds_write_b128 v22, v[120:123] offset:2048
    ds_write_b32 v23, v20 offset:3072
    v_lshl_add_u32 v22, v1, 4, s32
    v_lshl_add_u32 v23, v1, 2, s32
    s_lshl_b32 s32, s26, 3
    s_add_u32 s32, s32, s52
    s_lshl_b32 s32, s32, 7
    s_and_b32 s33, s25, 3
    s_lshl_b32 s33, s33, 2
    s_add_u32 s32, s32, s33
    s_add_u32 s32, s32, 26247168
    s_waitcnt lgkmcnt(0)
    s_barrier
    ds_read_b32 v124, v23 offset:3072
    ds_read_b128 v[120:123], v22 offset:2048
    ds_read_b128 v[112:115], v22 offset:0
    ds_read_b128 v[116:119], v22 offset:1024
    s_waitcnt lgkmcnt(3)
    v_max_f32 v26, v19, v124
    v_sub_f32 v28, v19, v26
    v_sub_f32 v29, v124, v26
    v_exp_f32 v28, v28
    v_exp_f32 v29, v29
    s_waitcnt lgkmcnt(2)
    v_mul_f32 v26, v104, v28
    v_fmac_f32 v26, v120, v29
    v_mov_b32 v27, v26
    s_nop 1
    v_permlane32_swap_b32 v27, v26
    s_nop 1
    v_rcp_f32 v26, v26
    s_nop 0
    v_mul_f32 v28, v28, v26
    v_mul_f32 v29, v29, v26
    s_waitcnt lgkmcnt(0)
    v_pk_mul_f32 v[96:97], v[96:97], v[28:29] op_sel:[0,0] op_sel_hi:[1,0]
    v_pk_fma_f32 v[96:97], v[112:113], v[28:29], v[96:97] op_sel:[0,1,0] op_sel_hi:[1,1,1]
    v_pk_mul_f32 v[98:99], v[98:99], v[28:29] op_sel:[0,0] op_sel_hi:[1,0]
    v_pk_fma_f32 v[98:99], v[114:115], v[28:29], v[98:99] op_sel:[0,1,0] op_sel_hi:[1,1,1]
    v_pk_mul_f32 v[100:101], v[100:101], v[28:29] op_sel:[0,0] op_sel_hi:[1,0]
    v_pk_fma_f32 v[100:101], v[116:117], v[28:29], v[100:101] op_sel:[0,1,0] op_sel_hi:[1,1,1]
    v_pk_mul_f32 v[102:103], v[102:103], v[28:29] op_sel:[0,0] op_sel_hi:[1,0]
    v_pk_fma_f32 v[102:103], v[118:119], v[28:29], v[102:103] op_sel:[0,1,0] op_sel_hi:[1,1,1]
    v_pk_mul_f32 v[104:105], v[104:105], v[28:29] op_sel:[0,0] op_sel_hi:[1,0]
    v_pk_fma_f32 v[104:105], v[120:121], v[28:29], v[104:105] op_sel:[0,1,0] op_sel_hi:[1,1,1]
    v_pk_mul_f32 v[106:107], v[106:107], v[28:29] op_sel:[0,0] op_sel_hi:[1,0]
    v_pk_fma_f32 v[106:107], v[122:123], v[28:29], v[106:107] op_sel:[0,1,0] op_sel_hi:[1,1,1]
    v_cvt_pk_bf16_f32 v128, v96, v97
    v_cvt_pk_bf16_f32 v129, v98, v99
    v_cvt_pk_bf16_f32 v130, v100, v101
    v_cvt_pk_bf16_f32 v131, v102, v103
    v_cvt_pk_bf16_f32 v132, v104, v105
    v_cvt_pk_bf16_f32 v133, v106, v107
    s_mov_b32 s31, 7864320
    buffer_store_dwordx4 v[128:131], v24, s[16:19], s31 offen sc1
    s_mov_b64 exec, 0xffffffff
    buffer_store_dwordx2 v[132:133], v25, s[16:19], s31 offen sc1
    s_mov_b64 exec, -1
    s_barrier
    s_cmp_lt_u32 s24, 4
    s_cbranch_scc1 L_kf_p3
    v_lshlrev_b32 v4, 4, v1
    s_and_b32 s40, s24, 3
    s_mul_i32 s38, s57, 102400
    s_add_u32 s38, s38, 19922944
    s_mul_i32 s39, s59, 122880
    s_add_u32 s39, s39, 20971520
    s_mul_i32 s42, s57, 245760
    s_add_u32 s42, s42, 23068672
    v_add_u32 v5, 4096, v4
    v_mov_b32 v26, 0
    v_mov_b32 v27, 1
    s_waitcnt vmcnt(0)
    s_mov_b64 exec, 1
    buffer_store_dword v27, v26, s[16:19], s32 offen sc1
    s_mov_b64 exec, -1
    s_add_u32 s33, s61, 9
    s_add_u32 s33, s33, s40
    s_mul_i32 s34, s40, 3072
    s_add_u32 m0, s34, 0
    s_sub_u32 s31, 13, s40
    s_lshr_b32 s31, s31, 2
    s_mul_i32 s33, s33, 3072
L_run_50:
    s_sub_u32 s34, s33, 122880
    s_cselect_b32 s33, s33, s34
    s_add_u32 s34, s33, s39
    s_add_u32 s33, s33, 12288
    buffer_load_dwordx4 v4, s[16:19], s34 offen offset:0  lds
    buffer_load_dwordx4 v4, s[16:19], s34 offen offset:1024  lds
    buffer_load_dwordx4 v4, s[16:19], s34 offen offset:2048  lds
    s_sub_u32 s31, s31, 1
    s_add_u32 m0, m0, 12288
    s_cmp_lg_u32 s31, 0
    s_cbranch_scc1 L_run_50
L_run_50_e:
    s_add_u32 s33, s61, 0
    s_add_u32 s33, s33, s40
    s_mul_i32 s34, s40, 3072
    s_add_u32 m0, s34, 71680
    s_sub_u32 s31, 6, s40
    s_lshr_b32 s31, s31, 2
    s_cbranch_scc0 L_run_51_e
    s_mul_i32 s33, s33, 3072
L_run_51:
    s_sub_u32 s34, s33, 122880
    s_cselect_b32 s33, s33, s34
    s_add_u32 s34, s33, s39
    s_add_u32 s33, s33, 12288
    buffer_load_dwordx4 v4, s[16:19], s34 offen offset:0  lds
    buffer_load_dwordx4 v4, s[16:19], s34 offen offset:1024  lds
    buffer_load_dwordx4 v4, s[16:19], s34 offen offset:2048  lds
    s_sub_u32 s31, s31, 1
    s_add_u32 m0, m0, 12288
    s_cmp_lg_u32 s31, 0
    s_cbranch_scc1 L_run_51
L_run_51_e:
    s_add_u32 s33, s61, 3
    s_add_u32 s33, s33, s40
    s_mul_i32 s34, s40, 3072
    s_add_u32 m0, s34, 143360
    s_sub_u32 s31, 9, s40
    s_lshr_b32 s31, s31, 2
    s_mul_i32 s33, s33, 3072
L_run_52:
    s_sub_u32 s34, s33, 122880
    s_cselect_b32 s33, s33, s34
    s_add_u32 s34, s33, s39
    s_add_u32 s33, s33, 12288
    buffer_load_dwordx4 v4, s[16:19], s34 offen offset:0  lds
    buffer_load_dwordx4 v4, s[16:19], s34 offen offset:1024  lds
    buffer_load_dwordx4 v4, s[16:19], s34 offen offset:2048  lds
    s_sub_u32 s31, s31, 1
    s_add_u32 m0, m0, 12288
    s_cmp_lg_u32 s31, 0
    s_cbranch_scc1 L_run_52
L_run_52_e:
    s_barrier
    s_barrier
    s_add_u32 s33, s61, 19
    s_add_u32 s33, s33, s40
    s_mul_i32 s34, s40, 3072
    s_add_u32 m0, s34, 30720
    s_sub_u32 s31, 13, s40
    s_lshr_b32 s31, s31, 2
    s_mul_i32 s33, s33, 3072
L_run_53:
    s_sub_u32 s34, s33, 122880
    s_cselect_b32 s33, s33, s34
    s_add_u32 s34, s33, s39
    s_add_u32 s33, s33, 12288
    buffer_load_dwordx4 v4, s[16:19], s34 offen offset:0  lds
    buffer_load_dwordx4 v4, s[16:19], s34 offen offset:1024  lds
    buffer_load_dwordx4 v4, s[16:19], s34 offen offset:2048  lds
    s_sub_u32 s31, s31, 1
    s_add_u32 m0, m0, 12288
    s_cmp_lg_u32 s31, 0
    s_cbranch_scc1 L_run_53
L_run_53_e:
    s_add_u32 s33, s61, 29
    s_add_u32 s33, s33, s40
    s_mul_i32 s34, s40, 3072
    s_add_u32 m0, s34, 81920
    s_sub_u32 s31, 13, s40
    s_lshr_b32 s31, s31, 2
    s_mul_i32 s33, s33, 3072
L_run_54:
    s_sub_u32 s34, s33, 122880
    s_cselect_b32 s33, s33, s34
    s_add_u32 s34, s33, s39
    s_add_u32 s33, s33, 12288
    buffer_load_dwordx4 v4, s[16:19], s34 offen offset:0  lds
    buffer_load_dwordx4 v4, s[16:19], s34 offen offset:1024  lds
    buffer_load_dwordx4 v4, s[16:19], s34 offen offset:2048  lds
    s_sub_u32 s31, s31, 1
    s_add_u32 m0, m0, 12288
    s_cmp_lg_u32 s31, 0
    s_cbranch_scc1 L_run_54
L_run_54_e:
    s_barrier
    s_add_u32 s33, s61, 39
    s_add_u32 s33, s33, s40
    s_mul_i32 s34, s40, 3072
    s_add_u32 m0, s34, 112640
    s_sub_u32 s31, 4, s40
    s_lshr_b32 s31, s31, 2
    s_cbranch_scc0 L_run_55_e
    s_mul_i32 s33, s33, 3072
L_run_55:
    s_sub_u32 s34, s33, 122880
    s_cselect_b32 s33, s33, s34
    s_add_u32 s34, s33, s39
    s_add_u32 s33, s33, 12288
    buffer_load_dwordx4 v4, s[16:19], s34 offen offset:0  lds
    buffer_load_dwordx4 v4, s[16:19], s34 offen offset:1024  lds
    buffer_load_dwordx4 v4, s[16:19], s34 offen offset:2048  lds
    s_sub_u32 s31, s31, 1
    s_add_u32 m0, m0, 12288
    s_cmp_lg_u32 s31, 0
    s_cbranch_scc1 L_run_55
L_run_55_e:
    s_waitcnt vmcnt(0)
    s_barrier
    s_add_u32 s33, s62, 0
    s_add_u32 s33, s33, s40
    s_mul_i32 s34, s40, 5120
    s_add_u32 m0, s34, 115712
    s_sub_u32 s31, 8, s40
    s_lshr_b32 s31, s31, 2
    s_mul_i32 s33, s33, 5120
L_run_56:
    s_sub_u32 s34, s33, 245760
    s_cselect_b32 s33, s33, s34
    s_add_u32 s34, s33, s42
    s_add_u32 s33, s33, 20480
    buffer_load_dwordx4 v4, s[16:19], s34 offen offset:0  lds
    s_waitcnt vmcnt(8)
    buffer_load_dwordx4 v4, s[16:19], s34 offen offset:1024  lds
    s_waitcnt vmcnt(8)
    buffer_load_dwordx4 v4, s[16:19], s34 offen offset:2048  lds
    s_waitcnt vmcnt(8)
    buffer_load_dwordx4 v4, s[16:19], s34 offen offset:3072  lds
    s_waitcnt vmcnt(8)
    s_add_u32 m0, m0, 4096
    s_sub_u32 s31, s31, 1
    buffer_load_dwordx4 v5, s[16:19], s34 offen  lds
    s_add_u32 m0, m0, 16384
    s_cmp_lg_u32 s31, 0
    s_cbranch_scc1 L_run_56
L_run_56_e:
    s_add_u32 s33, s62, 5
    s_add_u32 s33, s33, s40
    s_mul_i32 s34, s40, 5120
    s_add_u32 m0, s34, 61440
    s_sub_u32 s31, 5, s40
    s_lshr_b32 s31, s31, 2
    s_cbranch_scc0 L_run_57_e
    s_mul_i32 s33, s33, 5120
L_run_57:
    s_sub_u32 s34, s33, 245760
    s_cselect_b32 s33, s33, s34
    s_add_u32 s34, s33, s42
    s_add_u32 s33, s33, 20480
    buffer_load_dwordx4 v4, s[16:19], s34 offen offset:0  lds
    s_waitcnt vmcnt(8)
    buffer_load_dwordx4 v4, s[16:19], s34 offen offset:1024  lds
    s_waitcnt vmcnt(8)
    buffer_load_dwordx4 v4, s[16:19], s34 offen offset:2048  lds
    s_waitcnt vmcnt(8)
    buffer_load_dwordx4 v4, s[16:19], s34 offen offset:3072  lds
    s_waitcnt vmcnt(8)
    s_add_u32 m0, m0, 4096
    s_sub_u32 s31, s31, 1
    buffer_load_dwordx4 v5, s[16:19], s34 offen  lds
    s_add_u32 m0, m0, 16384
    s_cmp_lg_u32 s31, 0
    s_cbranch_scc1 L_run_57
L_run_57_e:
    s_barrier
    s_add_u32 s33, s62, 7
    s_add_u32 s33, s33, s40
    s_mul_i32 s34, s40, 5120
    s_add_u32 m0, s34, 0
    s_sub_u32 s31, 9, s40
    s_lshr_b32 s31, s31, 2
    s_mul_i32 s33, s33, 5120
L_run_58:
    s_sub_u32 s34, s33, 245760
    s_cselect_b32 s33, s33, s34
    s_add_u32 s34, s33, s42
    s_add_u32 s33, s33, 20480
    buffer_load_dwordx4 v4, s[16:19], s34 offen offset:0  lds
    buffer_load_dwordx4 v4, s[16:19], s34 offen offset:1024  lds
    buffer_load_dwordx4 v4, s[16:19], s34 offen offset:2048  lds
    buffer_load_dwordx4 v4, s[16:19], s34 offen offset:3072  lds
    s_add_u32 m0, m0, 4096
    s_sub_u32 s31, s31, 1
    buffer_load_dwordx4 v5, s[16:19], s34 offen  lds
    s_add_u32 m0, m0, 16384
    s_cmp_lg_u32 s31, 0
    s_cbranch_scc1 L_run_58
L_run_58_e:
    s_add_u32 s33, s62, 13
    s_add_u32 s33, s33, s40
    s_mul_i32 s34, s40, 5120
    s_add_u32 m0, s34, 143360
    s_sub_u32 s31, 6, s40
    s_lshr_b32 s31, s31, 2
    s_cbranch_scc0 L_run_59_e
    s_mul_i32 s33, s33, 5120
L_run_59:
    s_sub_u32 s34, s33, 245760
    s_cselect_b32 s33, s33, s34
    s_add_u32 s34, s33, s42
    s_add_u32 s33, s33, 20480
    buffer_load_dwordx4 v4, s[16:19], s34 offen offset:0  lds
    buffer_load_dwordx4 v4, s[16:19], s34 offen offset:1024  lds
    buffer_load_dwordx4 v4, s[16:19], s34 offen offset:2048  lds
    buffer_load_dwordx4 v4, s[16:19], s34 offen offset:3072  lds
    s_add_u32 m0, m0, 4096
    s_sub_u32 s31, s31, 1
    buffer_load_dwordx4 v5, s[16:19], s34 offen  lds
    s_add_u32 m0, m0, 16384
    s_cmp_lg_u32 s31, 0
    s_cbranch_scc1 L_run_59
L_run_59_e:
    s_add_u32 s33, s62, 16
    s_add_u32 s33, s33, s40
    s_mul_i32 s34, s40, 5120
    s_add_u32 m0, s34, 71680
    s_sub_u32 s31, 5, s40
    s_lshr_b32 s31, s31, 2
    s_cbranch_scc0 L_run_60_e
    s_mul_i32 s33, s33, 5120
L_run_60:
    s_sub_u32 s34, s33, 245760
    s_cselect_b32 s33, s33, s34
    s_add_u32 s34, s33, s42
    s_add_u32 s33, s33, 20480
    buffer_load_dwordx4 v4, s[16:19], s34 offen offset:0  lds
    buffer_load_dwordx4 v4, s[16:19], s34 offen offset:1024  lds
    buffer_load_dwordx4 v4, s[16:19], s34 offen offset:2048  lds
    buffer_load_dwordx4 v4, s[16:19], s34 offen offset:3072  lds
    s_add_u32 m0, m0, 4096
    s_sub_u32 s31, s31, 1
    buffer_load_dwordx4 v5, s[16:19], s34 offen  lds
    s_add_u32 m0, m0, 16384
    s_cmp_lg_u32 s31, 0
    s_cbranch_scc1 L_run_60
L_run_60_e:
    s_barrier
    s_add_u32 s33, s62, 18
    s_add_u32 s33, s33, s40
    s_mul_i32 s34, s40, 5120
    s_add_u32 m0, s34, 30720
    s_sub_u32 s31, 9, s40
    s_lshr_b32 s31, s31, 2
    s_mul_i32 s33, s33, 5120
L_run_61:
    s_sub_u32 s34, s33, 245760
    s_cselect_b32 s33, s33, s34
    s_add_u32 s34, s33, s42
    s_add_u32 s33, s33, 20480
    buffer_load_dwordx4 v4, s[16:19], s34 offen offset:0  lds
    buffer_load_dwordx4 v4, s[16:19], s34 offen offset:1024  lds
    buffer_load_dwordx4 v4, s[16:19], s34 offen offset:2048  lds
    buffer_load_dwordx4 v4, s[16:19], s34 offen offset:3072  lds
    s_add_u32 m0, m0, 4096
    s_sub_u32 s31, s31, 1
    buffer_load_dwordx4 v5, s[16:19], s34 offen  lds
    s_add_u32 m0, m0, 16384
    s_cmp_lg_u32 s31, 0
    s_cbranch_scc1 L_run_61
L_run_61_e:
    s_add_u32 s33, s62, 24
    s_add_u32 s33, s33, s40
    s_mul_i32 s34, s40, 5120
    s_add_u32 m0, s34, 81920
    s_sub_u32 s31, 9, s40
    s_lshr_b32 s31, s31, 2
    s_mul_i32 s33, s33, 5120
L_run_62:
    s_sub_u32 s34, s33, 245760
    s_cselect_b32 s33, s33, s34
    s_add_u32 s34, s33, s42
    s_add_u32 s33, s33, 20480
    buffer_load_dwordx4 v4, s[16:19], s34 offen offset:0  lds
    buffer_load_dwordx4 v4, s[16:19], s34 offen offset:1024  lds
    buffer_load_dwordx4 v4, s[16:19], s34 offen offset:2048  lds
    buffer_load_dwordx4 v4, s[16:19], s34 offen offset:3072  lds
    s_add_u32 m0, m0, 4096
    s_sub_u32 s31, s31, 1
    buffer_load_dwordx4 v5, s[16:19], s34 offen  lds
    s_add_u32 m0, m0, 16384
    s_cmp_lg_u32 s31, 0
    s_cbranch_scc1 L_run_62
L_run_62_e:
    s_lshl_b32 s56, s52, 2
    s_and_b32 s31, s53, 3
    s_add_u32 s56, s56, s31
    s_lshl_b32 s56, s56, 2
    s_add_u32 s56, s56, s40
    s_waitcnt vmcnt(10)
    s_branch L_kf_p5odd
L_kfs_44:
    s_cmp_lg_u32 s27, 2
    s_cbranch_scc1 L_kfs_44_0
    s_setprio 1
    s_branch L_kfs_44_r
L_kfs_44_0:
    s_barrier
    s_setprio 2
    s_branch L_kfs_44_r
L_kfs_45:
    s_setprio 1
    s_branch L_kfs_45_r
L_kfs_46:
    s_barrier
    s_cmp_ge_u32 s24, 4
    s_cbranch_scc1 L_kf_nox2
    buffer_load_dwordx4 v[152:155], v162, s[8:11], 0 offen
    buffer_load_dwordx4 v[156:159], v162, s[8:11], 0 offen offset:16
    buffer_load_dwordx2 v[160:161], v162, s[8:11], 0 offen offset:32
L_kf_nox2:
    s_setprio 2
    s_branch L_kfs_46_r
L_kfs_47:
    s_setprio 1
    s_branch L_kfs_47_r
L_kfs_48:
    s_setprio 0
    s_branch L_kfs_48_r
L_kfs_49:
    s_setprio 0
    s_branch L_kfs_49_r
L_kf_fallback:
    s_mov_b32 s30, 1
    s_mul_i32 s34, s25, 163840
    v_mov_b32 v19, 0xff800000
    v_mov_b32 v20, 0xff800000
    s_mov_b32 s27, 0
    s_mov_b32 s33, s34
L_kf_fbloop:
    buffer_load_dwordx4 v[136:139], v16, s[16:19], s33 offen
    buffer_load_dwordx2 v[140:141], v17, s[16:19], s33 offen
    s_waitcnt vmcnt(0)
    v_mfma_f32_32x32x16_bf16 v[64:79], v[136:139], v[4:7], 0
    v_mfma_f32_32x32x16_bf16 v[80:95], v[136:139], v[10:13], 0
    v_mfma_f32_32x32x8_bf16 v[64:79], v[140:141], v[8:9], v[64:79]
    v_mfma_f32_32x32x8_bf16 v[80:95], v[140:141], v[14:15], v[80:95]
    s_add_u32 s33, s33, 2560
    s_nop 15
    v_max3_f32 v19, v19, v64, v65
    v_max3_f32 v19, v19, v66, v67
    v_max3_f32 v19, v19, v68, v69
    v_max3_f32 v19, v19, v70, v71
    v_max3_f32 v19, v19, v72, v73
    v_max3_f32 v19, v19, v74, v75
    v_max3_f32 v19, v19, v76, v77
    v_max3_f32 v19, v19, v78, v79
    v_max3_f32 v20, v20, v80, v81
    v_max3_f32 v20, v20, v82, v83
    v_max3_f32 v20, v20, v84, v85
    v_max3_f32 v20, v20, v86, v87
    v_max3_f32 v20, v20, v88, v89
    v_max3_f32 v20, v20, v90, v91
    v_max3_f32 v20, v20, v92, v93
    v_max3_f32 v20, v20, v94, v95
    s_add_u32 s27, s27, 1
    s_cmp_lt_u32 s27, 32
    s_cbranch_scc1 L_kf_fbloop
    v_mov_b32 v144, v31
    v_mov_b32 v145, v31
    v_mov_b32 v146, v31
    v_mov_b32 v147, v31
    v_mov_b32 v148, v31
    v_mov_b32 v149, v31
    v_mov_b32 v150, v31
    v_mov_b32 v151, v31
    v_mov_b32 v96, 0
    v_mov_b32 v97, 0
    v_mov_b32 v98, 0
    v_mov_b32 v99, 0
    v_mov_b32 v100, 0
    v_mov_b32 v101, 0
    v_mov_b32 v102, 0
    v_mov_b32 v103, 0
    v_mov_b32 v104, 0
    v_mov_b32 v105, 0
    v_mov_b32 v106, 0
    v_mov_b32 v107, 0
    v_mov_b32 v108, 0
    v_mov_b32 v109, 0
    v_mov_b32 v110, 0
    v_mov_b32 v111, 0
    v_mov_b32 v112, 0
    v_mov_b32 v113, 0
    v_mov_b32 v114, 0
    v_mov_b32 v115, 0
    v_mov_b32 v116, 0
    v_mov_b32 v117, 0
    v_mov_b32 v118, 0
    v_mov_b32 v119, 0
    v_mov_b32 v120, 0
    v_mov_b32 v121, 0
    v_mov_b32 v122, 0
    v_mov_b32 v123, 0
    v_mov_b32 v124, 0
    v_mov_b32 v125, 0
    v_mov_b32 v126, 0
    v_mov_b32 v127, 0
    v_mov_b32 v132, 0
    v_mov_b32 v133, 0
    v_mov_b32 v134, 0
    v_mov_b32 v135, 0
    v_mov_b32 v22, v19
    v_mov_b32 v23, v20
    s_nop 1
    v_permlane32_swap_b32 v19, v22
    v_permlane32_swap_b32 v20, v23
    s_nop 1
    v_max_f32 v19, v19, v22
    v_max_f32 v20, v20, v23
    v_sub_f32 v32, 0, v19
    v_sub_f32 v33, 0, v19
    v_sub_f32 v34, 0, v19
    v_sub_f32 v35, 0, v19
    v_sub_f32 v36, 0, v19
    v_sub_f32 v37, 0, v19
    v_sub_f32 v38, 0, v19
    v_sub_f32 v39, 0, v19
    v_sub_f32 v40, 0, v19
    v_sub_f32 v41, 0, v19
    v_sub_f32 v42, 0, v19
    v_sub_f32 v43, 0, v19
    v_sub_f32 v44, 0, v19
    v_sub_f32 v45, 0, v19
    v_sub_f32 v46, 0, v19
    v_sub_f32 v47, 0, v19
    v_sub_f32 v48, 0, v20
    v_sub_f32 v49, 0, v20
    v_sub_f32 v50, 0, v20
    v_sub_f32 v51, 0, v20
    v_sub_f32 v52, 0, v20
    v_sub_f32 v53, 0, v20
    v_sub_f32 v54, 0, v20
    v_sub_f32 v55, 0, v20
    v_sub_f32 v56, 0, v20
    v_sub_f32 v57, 0, v20
    v_sub_f32 v58, 0, v20
    v_sub_f32 v59, 0, v20
    v_sub_f32 v60, 0, v20
    v_sub_f32 v61, 0, v20
    v_sub_f32 v62, 0, v20
    v_sub_f32 v63, 0, v20
    s_mov_b32 s27, 0
    s_mov_b32 s33, s34
L_kf_fbloop2:
    buffer_load_dwordx4 v[136:139], v16, s[16:19], s33 offen
    buffer_load_dwordx2 v[140:141], v17, s[16:19], s33 offen
    s_mov_b64 exec, s[36:37]
    buffer_load_dwordx4 v[144:147], v18, s[16:19], s33 offen
    buffer_load_dwordx4 v[148:151], v18, s[16:19], s33 offen offset:640
    s_mov_b64 exec, -1
    s_waitcnt vmcnt(0)
    v_mfma_f32_32x32x16_bf16 v[64:79], v[136:139], v[4:7], v[32:47]
    v_mfma_f32_32x32x16_bf16 v[80:95], v[136:139], v[10:13], v[48:63]
    v_mfma_f32_32x32x8_bf16 v[64:79], v[140:141], v[8:9], v[64:79]
    v_mfma_f32_32x32x8_bf16 v[80:95], v[140:141], v[14:15], v[80:95]
    s_add_u32 s33, s33, 2560
    s_nop 15
    v_exp_f32 v64, v64
    v_exp_f32 v65, v65
    v_exp_f32 v66, v66
    v_exp_f32 v67, v67
    v_exp_f32 v68, v68
    v_exp_f32 v69, v69
    v_exp_f32 v70, v70
    v_exp_f32 v71, v71
    v_exp_f32 v72, v72
    v_exp_f32 v73, v73
    v_exp_f32 v74, v74
    v_exp_f32 v75, v75
    v_exp_f32 v76, v76
    v_exp_f32 v77, v77
    v_exp_f32 v78, v78
    v_exp_f32 v79, v79
    s_nop 0
    v_cvt_pk_bf16_f32 v128, v64, v65
    v_cvt_pk_bf16_f32 v129, v66, v67
    v_cvt_pk_bf16_f32 v130, v68, v69
    v_cvt_pk_bf16_f32 v131, v70, v71
    v_cvt_pk_bf16_f32 v132, v72, v73
    v_cvt_pk_bf16_f32 v133, v74, v75
    v_cvt_pk_bf16_f32 v134, v76, v77
    v_cvt_pk_bf16_f32 v135, v78, v79
    s_nop 1
    v_mfma_f32_32x32x16_bf16 v[96:111], v[144:147], v[128:131], v[96:111]
    v_mfma_f32_32x32x16_bf16 v[96:111], v[148:151], v[132:135], v[96:111]
    v_exp_f32 v80, v80
    v_exp_f32 v81, v81
    v_exp_f32 v82, v82
    v_exp_f32 v83, v83
    v_exp_f32 v84, v84
    v_exp_f32 v85, v85
    v_exp_f32 v86, v86
    v_exp_f32 v87, v87
    v_exp_f32 v88, v88
    v_exp_f32 v89, v89
    v_exp_f32 v90, v90
    v_exp_f32 v91, v91
    v_exp_f32 v92, v92
    v_exp_f32 v93, v93
    v_exp_f32 v94, v94
    v_exp_f32 v95, v95
    s_nop 0
    v_cvt_pk_bf16_f32 v128, v80, v81
    v_cvt_pk_bf16_f32 v129, v82, v83
    v_cvt_pk_bf16_f32 v130, v84, v85
    v_cvt_pk_bf16_f32 v131, v86, v87
    v_cvt_pk_bf16_f32 v132, v88, v89
    v_cvt_pk_bf16_f32 v133, v90, v91
    v_cvt_pk_bf16_f32 v134, v92, v93
    v_cvt_pk_bf16_f32 v135, v94, v95
    s_nop 1
    v_mfma_f32_32x32x16_bf16 v[112:127], v[144:147], v[128:131], v[112:127]
    v_mfma_f32_32x32x16_bf16 v[112:127], v[148:151], v[132:135], v[112:127]
    s_add_u32 s27, s27, 1
    s_cmp_lt_u32 s27, 32
    s_cbranch_scc1 L_kf_fbloop2
    s_nop 15
    s_branch L_kf_store
L_kf_p3:
    v_lshlrev_b32 v8, 4, v1
    v_mov_b32 v9, v8
    v_add_u32 v10, 65536, v8
    v_add_u32 v11, 131072, v8
    v_and_b32 v15, 15, v1
    v_lshrrev_b32 v3, 4, v1
    s_mul_i32 s31, s56, 20480
    s_add_u32 s55, s31, 7864320
    v_mov_b32 v12, v162
    s_waitcnt vmcnt(2)
    v_mov_b32 v16, v152
    v_mov_b32 v17, v153
    v_mov_b32 v18, v154
    v_mov_b32 v19, v155
    v_mov_b32 v20, v156
    v_mov_b32 v21, v157
    v_mov_b32 v22, v158
    v_mov_b32 v23, v159
    v_mov_b32 v24, v160
    v_mov_b32 v25, v161
    s_lshr_b32 s34, s56, 1
    s_mul_i32 s31, s34, 40960
    s_mul_i32 s33, s57, 5120
    s_add_u32 s31, s31, s33
    s_and_b32 s33, s56, 1
    s_lshl_b32 s33, s33, 8
    s_add_u32 s31, s31, s33
    s_add_u32 s31, s31, 10485760
    v_lshl_add_u32 v5, v15, 4, s31
    v_lshl_add_u32 v13, v3, 10, v5
    v_lshrrev_b32 v7, 5, v1
    v_lshl_add_u32 v5, v7, 9, v5
    v_and_b32 v7, 1, v3
    v_lshl_add_u32 v5, v7, 3, v5
    v_add_u32 v14, 4096, v5
    v_mov_b32 v2, 0
    v_mov_b32 v3, 1
    s_waitcnt vmcnt(0)
    s_mov_b64 exec, 1
    buffer_store_dword v3, v2, s[16:19], s32 offen sc1
    s_mov_b64 exec, -1
    v_mov_b32 v32, 0
    v_mov_b32 v33, 0
    v_mov_b32 v34, 0
    v_mov_b32 v35, 0
    v_mov_b32 v36, 0
    v_mov_b32 v37, 0
    v_mov_b32 v38, 0
    v_mov_b32 v39, 0
    v_mov_b32 v40, 0
    v_mov_b32 v41, 0
    v_mov_b32 v42, 0
    v_mov_b32 v43, 0
    v_mov_b32 v44, 0
    v_mov_b32 v45, 0
    v_mov_b32 v46, 0
    v_mov_b32 v47, 0
    v_mov_b32 v48, 0
    v_mov_b32 v49, 0
    v_mov_b32 v50, 0
    v_mov_b32 v51, 0
    s_mov_b32 s38, s55
    s_add_u32 s39, s55, 20480
    s_lshl_b32 s31, s60, 10
    s_add_u32 s55, s55, s31
    v_lshrrev_b32 v6, 4, v1
    v_lshlrev_b32 v6, 8, v6
    v_lshl_add_u32 v6, v15, 3, v6
    s_barrier
    buffer_load_dwordx4 v[112:115], v8, s[16:19], s55 offen offset:0 sc1
    buffer_load_dwordx4 v[116:119], v8, s[16:19], s55 offen offset:1024 sc1
    buffer_load_dwordx4 v[120:123], v8, s[16:19], s55 offen offset:2048 sc1
    buffer_load_dwordx4 v[124:127], v8, s[16:19], s55 offen offset:3072 sc1
    s_add_u32 s55, s55, 4096
    buffer_load_dwordx4 v[128:131], v8, s[16:19], s55 offen offset:0 sc1
    buffer_load_dwordx4 v[132:135], v8, s[16:19], s55 offen offset:1024 sc1
    buffer_load_dwordx4 v[136:139], v8, s[16:19], s55 offen offset:2048 sc1
    buffer_load_dwordx4 v[140:143], v8, s[16:19], s55 offen offset:3072 sc1
    s_add_u32 s55, s55, 4096
    buffer_load_dwordx4 v[144:147], v8, s[16:19], s55 offen offset:0 sc1
    buffer_load_dwordx4 v[148:151], v8, s[16:19], s55 offen offset:1024 sc1
    buffer_load_dwordx4 v[152:155], v8, s[16:19], s55 offen offset:2048 sc1
    buffer_load_dwordx4 v[156:159], v8, s[16:19], s55 offen offset:3072 sc1
    s_add_u32 s55, s55, 4096
    ds_read_b128 v[52:55], v9 offset:30720
    ds_read_b128 v[56:59], v9 offset:31744
    ds_read_b128 v[60:63], v9 offset:32768
    ds_read_b128 v[64:67], v9 offset:33792
    ds_read_b128 v[68:71], v9 offset:34816
    ds_read_b128 v[72:75], v9 offset:35840
    ds_read_b128 v[76:79], v9 offset:36864
    ds_read_b128 v[80:83], v9 offset:37888
    ds_read_b128 v[84:87], v9 offset:38912
    ds_read_b128 v[88:91], v9 offset:39936
    s_waitcnt vmcnt(11) lgkmcnt(5)
    v_mfma_f32_16x16x32_bf16 v[32:35], v[52:55], v[112:115], v[32:35]
    ds_read_b128 v[92:95], v9 offset:40960
    v_mfma_f32_16x16x32_bf16 v[36:39], v[56:59], v[112:115], v[36:39]
    ds_read_b128 v[96:99], v9 offset:41984
    v_mfma_f32_16x16x32_bf16 v[40:43], v[60:63], v[112:115], v[40:43]
    ds_read_b128 v[100:103], v9 offset:43008
    v_mfma_f32_16x16x32_bf16 v[44:47], v[64:67], v[112:115], v[44:47]
    ds_read_b128 v[104:107], v9 offset:44032
    v_mfma_f32_16x16x32_bf16 v[48:51], v[68:71], v[112:115], v[48:51]
    ds_read_b128 v[108:111], v9 offset:45056
    buffer_load_dwordx4 v[160:163], v8, s[16:19], s55 offen offset:0 sc1
    s_waitcnt vmcnt(11) lgkmcnt(5)
    v_mfma_f32_16x16x32_bf16 v[32:35], v[72:75], v[116:119], v[32:35]
    ds_read_b128 v[52:55], v9 offset:46080
    v_mfma_f32_16x16x32_bf16 v[36:39], v[76:79], v[116:119], v[36:39]
    ds_read_b128 v[56:59], v9 offset:47104
    v_mfma_f32_16x16x32_bf16 v[40:43], v[80:83], v[116:119], v[40:43]
    ds_read_b128 v[60:63], v9 offset:48128
    v_mfma_f32_16x16x32_bf16 v[44:47], v[84:87], v[116:119], v[44:47]
    ds_read_b128 v[64:67], v9 offset:49152
    v_mfma_f32_16x16x32_bf16 v[48:51], v[88:91], v[116:119], v[48:51]
    ds_read_b128 v[68:71], v9 offset:50176
    buffer_load_dwordx4 v[164:167], v8, s[16:19], s55 offen offset:1024 sc1
    s_waitcnt vmcnt(11) lgkmcnt(5)
    v_mfma_f32_16x16x32_bf16 v[32:35], v[92:95], v[120:123], v[32:35]
    ds_read_b128 v[72:75], v9 offset:51200
    v_mfma_f32_16x16x32_bf16 v[36:39], v[96:99], v[120:123], v[36:39]
    ds_read_b128 v[76:79], v9 offset:52224
    v_mfma_f32_16x16x32_bf16 v[40:43], v[100:103], v[120:123], v[40:43]
    ds_read_b128 v[80:83], v9 offset:53248
    v_mfma_f32_16x16x32_bf16 v[44:47], v[104:107], v[120:123], v[44:47]
    ds_read_b128 v[84:87], v9 offset:54272
    v_mfma_f32_16x16x32_bf16 v[48:51], v[108:111], v[120:123], v[48:51]
    ds_read_b128 v[88:91], v9 offset:55296
    buffer_load_dwordx4 v[112:115], v8, s[16:19], s55 offen offset:2048 sc1
    s_waitcnt vmcnt(11) lgkmcnt(5)
    v_mfma_f32_16x16x32_bf16 v[32:35], v[52:55], v[124:127], v[32:35]
    ds_read_b128 v[92:95], v9 offset:56320
    v_mfma_f32_16x16x32_bf16 v[36:39], v[56:59], v[124:127], v[36:39]
    ds_read_b128 v[96:99], v9 offset:57344
    v_mfma_f32_16x16x32_bf16 v[40:43], v[60:63], v[124:127], v[40:43]
    ds_read_b128 v[100:103], v9 offset:58368
    v_mfma_f32_16x16x32_bf16 v[44:47], v[64:67], v[124:127], v[44:47]
    ds_read_b128 v[104:107], v9 offset:59392
    v_mfma_f32_16x16x32_bf16 v[48:51], v[68:71], v[124:127], v[48:51]
    ds_read_b128 v[108:111], v9 offset:60416
    buffer_load_dwordx4 v[116:119], v8, s[16:19], s55 offen offset:3072 sc1
    s_add_u32 s55, s55, 4096
    s_waitcnt vmcnt(11) lgkmcnt(5)
    v_mfma_f32_16x16x32_bf16 v[32:35], v[72:75], v[128:131], v[32:35]
    ds_read_b128 v[52:55], v10 offset:16384
    v_mfma_f32_16x16x32_bf16 v[36:39], v[76:79], v[128:131], v[36:39]
    ds_read_b128 v[56:59], v10 offset:17408
    v_mfma_f32_16x16x32_bf16 v[40:43], v[80:83], v[128:131], v[40:43]
    ds_read_b128 v[60:63], v10 offset:18432
    v_mfma_f32_16x16x32_bf16 v[44:47], v[84:87], v[128:131], v[44:47]
    ds_read_b128 v[64:67], v10 offset:19456
    v_mfma_f32_16x16x32_bf16 v[48:51], v[88:91], v[128:131], v[48:51]
    ds_read_b128 v[68:71], v10 offset:20480
    buffer_load_dwordx2 v[120:121], v6, s[16:19], s55 offen offset:0 sc1
    buffer_load_dwordx2 v[122:123], v6, s[16:19], s55 offen offset:128 sc1
    s_waitcnt vmcnt(12) lgkmcnt(5)
    v_mfma_f32_16x16x32_bf16 v[32:35], v[92:95], v[132:135], v[32:35]
    ds_read_b128 v[72:75], v10 offset:21504
    v_mfma_f32_16x16x32_bf16 v[36:39], v[96:99], v[132:135], v[36:39]
    ds_read_b128 v[76:79], v10 offset:22528
    v_mfma_f32_16x16x32_bf16 v[40:43], v[100:103], v[132:135], v[40:43]
    ds_read_b128 v[80:83], v10 offset:23552
    v_mfma_f32_16x16x32_bf16 v[44:47], v[104:107], v[132:135], v[44:47]
    ds_read_b128 v[84:87], v10 offset:24576
    v_mfma_f32_16x16x32_bf16 v[48:51], v[108:111], v[132:135], v[48:51]
    ds_read_b128 v[88:91], v10 offset:25600
    buffer_load_dwordx2 v[124:125], v6, s[16:19], s55 offen offset:1024 sc1
    buffer_load_dwordx2 v[126:127], v6, s[16:19], s55 offen offset:1152 sc1
    s_waitcnt vmcnt(13) lgkmcnt(5)
    v_mfma_f32_16x16x32_bf16 v[32:35], v[52:55], v[136:139], v[32:35]
    ds_read_b128 v[92:95], v10 offset:26624
    v_mfma_f32_16x16x32_bf16 v[36:39], v[56:59], v[136:139], v[36:39]
    ds_read_b128 v[96:99], v10 offset:27648
    v_mfma_f32_16x16x32_bf16 v[40:43], v[60:63], v[136:139], v[40:43]
    ds_read_b128 v[100:103], v10 offset:28672
    v_mfma_f32_16x16x32_bf16 v[44:47], v[64:67], v[136:139], v[44:47]
    ds_read_b128 v[104:107], v10 offset:29696
    v_mfma_f32_16x16x32_bf16 v[48:51], v[68:71], v[136:139], v[48:51]
    ds_read_b128 v[108:111], v10 offset:30720
    buffer_load_dwordx2 v[128:129], v6, s[16:19], s55 offen offset:2048 sc1
    buffer_load_dwordx2 v[130:131], v6, s[16:19], s55 offen offset:2176 sc1
    s_waitcnt vmcnt(14) lgkmcnt(5)
    v_mfma_f32_16x16x32_bf16 v[32:35], v[72:75], v[140:143], v[32:35]
    ds_read_b128 v[52:55], v10 offset:31744
    v_mfma_f32_16x16x32_bf16 v[36:39], v[76:79], v[140:143], v[36:39]
    ds_read_b128 v[56:59], v10 offset:32768
    v_mfma_f32_16x16x32_bf16 v[40:43], v[80:83], v[140:143], v[40:43]
    ds_read_b128 v[60:63], v10 offset:33792
    v_mfma_f32_16x16x32_bf16 v[44:47], v[84:87], v[140:143], v[44:47]
    ds_read_b128 v[64:67], v10 offset:34816
    v_mfma_f32_16x16x32_bf16 v[48:51], v[88:91], v[140:143], v[48:51]
    ds_read_b128 v[68:71], v10 offset:35840
    buffer_load_dwordx2 v[132:133], v6, s[16:19], s55 offen offset:3072 sc1
    buffer_load_dwordx2 v[134:135], v6, s[16:19], s55 offen offset:3200 sc1
    s_add_u32 s55, s55, 4096
    s_waitcnt vmcnt(15) lgkmcnt(5)
    v_mfma_f32_16x16x32_bf16 v[32:35], v[92:95], v[144:147], v[32:35]
    ds_read_b128 v[72:75], v10 offset:36864
    v_mfma_f32_16x16x32_bf16 v[36:39], v[96:99], v[144:147], v[36:39]
    ds_read_b128 v[76:79], v10 offset:37888
    v_mfma_f32_16x16x32_bf16 v[40:43], v[100:103], v[144:147], v[40:43]
    ds_read_b128 v[80:83], v10 offset:38912
    v_mfma_f32_16x16x32_bf16 v[44:47], v[104:107], v[144:147], v[44:47]
    ds_read_b128 v[84:87], v10 offset:39936
    v_mfma_f32_16x16x32_bf16 v[48:51], v[108:111], v[144:147], v[48:51]
    ds_read_b128 v[88:91], v10 offset:40960
    s_waitcnt vmcnt(14) lgkmcnt(5)
    v_mfma_f32_16x16x32_bf16 v[32:35], v[52:55], v[148:151], v[32:35]
    ds_read_b128 v[92:95], v10 offset:41984
    v_mfma_f32_16x16x32_bf16 v[36:39], v[56:59], v[148:151], v[36:39]
    ds_read_b128 v[96:99], v10 offset:43008
    v_mfma_f32_16x16x32_bf16 v[40:43], v[60:63], v[148:151], v[40:43]
    ds_read_b128 v[100:103], v10 offset:44032
    v_mfma_f32_16x16x32_bf16 v[44:47], v[64:67], v[148:151], v[44:47]
    ds_read_b128 v[104:107], v10 offset:45056
    v_mfma_f32_16x16x32_bf16 v[48:51], v[68:71], v[148:151], v[48:51]
    ds_read_b128 v[108:111], v10 offset:46080
    s_waitcnt vmcnt(13) lgkmcnt(5)
    v_mfma_f32_16x16x32_bf16 v[32:35], v[72:75], v[152:155], v[32:35]
    ds_read_b128 v[52:55], v10 offset:47104
    v_mfma_f32_16x16x32_bf16 v[36:39], v[76:79], v[152:155], v[36:39]
    ds_read_b128 v[56:59], v10 offset:48128
    v_mfma_f32_16x16x32_bf16 v[40:43], v[80:83], v[152:155], v[40:43]
    ds_read_b128 v[60:63], v10 offset:49152
    v_mfma_f32_16x16x32_bf16 v[44:47], v[84:87], v[152:155], v[44:47]
    ds_read_b128 v[64:67], v10 offset:50176
    v_mfma_f32_16x16x32_bf16 v[48:51], v[88:91], v[152:155], v[48:51]
    ds_read_b128 v[68:71], v10 offset:51200
    s_waitcnt vmcnt(12) lgkmcnt(5)
    s_barrier
    v_mfma_f32_16x16x32_bf16 v[32:35], v[92:95], v[156:159], v[32:35]
    ds_read_b128 v[72:75], v10 offset:52224
    v_mfma_f32_16x16x32_bf16 v[36:39], v[96:99], v[156:159], v[36:39]
    ds_read_b128 v[76:79], v10 offset:53248
    v_mfma_f32_16x16x32_bf16 v[40:43], v[100:103], v[156:159], v[40:43]
    ds_read_b128 v[80:83], v10 offset:54272
    v_mfma_f32_16x16x32_bf16 v[44:47], v[104:107], v[156:159], v[44:47]
    ds_read_b128 v[84:87], v10 offset:55296
    v_mfma_f32_16x16x32_bf16 v[48:51], v[108:111], v[156:159], v[48:51]
    ds_read_b128 v[88:91], v10 offset:56320
    s_waitcnt vmcnt(11) lgkmcnt(5)
    v_mfma_f32_16x16x32_bf16 v[32:35], v[52:55], v[160:163], v[32:35]
    ds_read_b128 v[92:95], v10 offset:57344
    v_mfma_f32_16x16x32_bf16 v[36:39], v[56:59], v[160:163], v[36:39]
    ds_read_b128 v[96:99], v10 offset:58368
    v_mfma_f32_16x16x32_bf16 v[40:43], v[60:63], v[160:163], v[40:43]
    ds_read_b128 v[100:103], v10 offset:59392
    v_mfma_f32_16x16x32_bf16 v[44:47], v[64:67], v[160:163], v[44:47]
    ds_read_b128 v[104:107], v10 offset:60416
    v_mfma_f32_16x16x32_bf16 v[48:51], v[68:71], v[160:163], v[48:51]
    ds_read_b128 v[108:111], v10 offset:61440
    s_waitcnt vmcnt(10) lgkmcnt(5)
    v_mfma_f32_16x16x32_bf16 v[32:35], v[72:75], v[164:167], v[32:35]
    ds_read_b128 v[52:55], v10 offset:62464
    v_mfma_f32_16x16x32_bf16 v[36:39], v[76:79], v[164:167], v[36:39]
    ds_read_b128 v[56:59], v10 offset:63488
    v_mfma_f32_16x16x32_bf16 v[40:43], v[80:83], v[164:167], v[40:43]
    ds_read_b128 v[60:63], v10 offset:64512
    v_mfma_f32_16x16x32_bf16 v[44:47], v[84:87], v[164:167], v[44:47]
    ds_read_b128 v[64:67], v11 offset:0
    v_mfma_f32_16x16x32_bf16 v[48:51], v[88:91], v[164:167], v[48:51]
    ds_read_b128 v[68:71], v11 offset:1024
    s_waitcnt vmcnt(9) lgkmcnt(5)
    v_mfma_f32_16x16x32_bf16 v[32:35], v[92:95], v[112:115], v[32:35]
    ds_read_b128 v[72:75], v11 offset:2048
    v_mfma_f32_16x16x32_bf16 v[36:39], v[96:99], v[112:115], v[36:39]
    ds_read_b128 v[76:79], v11 offset:3072
    v_mfma_f32_16x16x32_bf16 v[40:43], v[100:103], v[112:115], v[40:43]
    ds_read_b128 v[80:83], v11 offset:4096
    v_mfma_f32_16x16x32_bf16 v[44:47], v[104:107], v[112:115], v[44:47]
    ds_read_b128 v[84:87], v11 offset:5120
    v_mfma_f32_16x16x32_bf16 v[48:51], v[108:111], v[112:115], v[48:51]
    ds_read_b128 v[88:91], v11 offset:6144
    s_waitcnt vmcnt(8) lgkmcnt(5)
    v_mfma_f32_16x16x32_bf16 v[32:35], v[52:55], v[116:119], v[32:35]
    ds_read_b128 v[92:95], v11 offset:7168
    v_mfma_f32_16x16x32_bf16 v[36:39], v[56:59], v[116:119], v[36:39]
    ds_read_b128 v[96:99], v11 offset:8192
    v_mfma_f32_16x16x32_bf16 v[40:43], v[60:63], v[116:119], v[40:43]
    ds_read_b128 v[100:103], v11 offset:9216
    v_mfma_f32_16x16x32_bf16 v[44:47], v[64:67], v[116:119], v[44:47]
    ds_read_b128 v[104:107], v11 offset:10240
    v_mfma_f32_16x16x32_bf16 v[48:51], v[68:71], v[116:119], v[48:51]
    ds_read_b128 v[108:111], v11 offset:11264
    s_waitcnt vmcnt(6) lgkmcnt(5)
    v_mfma_f32_16x16x32_bf16 v[32:35], v[72:75], v[120:123], v[32:35]
    ds_read_b128 v[52:55], v9 offset:61440
    v_mfma_f32_16x16x32_bf16 v[36:39], v[76:79], v[120:123], v[36:39]
    ds_read_b128 v[56:59], v9 offset:62464
    v_mfma_f32_16x16x32_bf16 v[40:43], v[80:83], v[120:123], v[40:43]
    ds_read_b128 v[60:63], v9 offset:63488
    v_mfma_f32_16x16x32_bf16 v[44:47], v[84:87], v[120:123], v[44:47]
    ds_read_b128 v[64:67], v9 offset:64512
    v_mfma_f32_16x16x32_bf16 v[48:51], v[88:91], v[120:123], v[48:51]
    ds_read_b128 v[68:71], v10 offset:0
    s_waitcnt vmcnt(4) lgkmcnt(5)
    v_mfma_f32_16x16x32_bf16 v[32:35], v[92:95], v[124:127], v[32:35]
    ds_read_b128 v[72:75], v10 offset:1024
    v_mfma_f32_16x16x32_bf16 v[36:39], v[96:99], v[124:127], v[36:39]
    ds_read_b128 v[76:79], v10 offset:2048
    v_mfma_f32_16x16x32_bf16 v[40:43], v[100:103], v[124:127], v[40:43]
    ds_read_b128 v[80:83], v10 offset:3072
    v_mfma_f32_16x16x32_bf16 v[44:47], v[104:107], v[124:127], v[44:47]
    ds_read_b128 v[84:87], v10 offset:4096
    v_mfma_f32_16x16x32_bf16 v[48:51], v[108:111], v[124:127], v[48:51]
    ds_read_b128 v[88:91], v10 offset:5120
    s_waitcnt vmcnt(2) lgkmcnt(5)
    v_mfma_f32_16x16x32_bf16 v[32:35], v[52:55], v[128:131], v[32:35]
    v_mfma_f32_16x16x32_bf16 v[36:39], v[56:59], v[128:131], v[36:39]
    v_mfma_f32_16x16x32_bf16 v[40:43], v[60:63], v[128:131], v[40:43]
    v_mfma_f32_16x16x32_bf16 v[44:47], v[64:67], v[128:131], v[44:47]
    v_mfma_f32_16x16x32_bf16 v[48:51], v[68:71], v[128:131], v[48:51]
    s_waitcnt vmcnt(0) lgkmcnt(0)
    v_mfma_f32_16x16x32_bf16 v[32:35], v[72:75], v[132:135], v[32:35]
    v_mfma_f32_16x16x32_bf16 v[36:39], v[76:79], v[132:135], v[36:39]
    v_mfma_f32_16x16x32_bf16 v[40:43], v[80:83], v[132:135], v[40:43]
    v_mfma_f32_16x16x32_bf16 v[44:47], v[84:87], v[132:135], v[44:47]
    v_mfma_f32_16x16x32_bf16 v[48:51], v[88:91], v[132:135], v[48:51]
    ds_read_b32 v2, v11 offset:32128
    s_mov_b32 s33, 0xffff0000
    v_lshlrev_b32 v52, 16, v16
    v_and_b32 v53, s33, v16
    v_lshlrev_b32 v54, 16, v17
    v_and_b32 v55, s33, v17
    v_lshlrev_b32 v56, 16, v18
    v_and_b32 v57, s33, v18
    v_lshlrev_b32 v58, 16, v19
    v_and_b32 v59, s33, v19
    v_lshlrev_b32 v60, 16, v20
    v_and_b32 v61, s33, v20
    v_lshlrev_b32 v62, 16, v21
    v_and_b32 v63, s33, v21
    v_lshlrev_b32 v64, 16, v22
    v_and_b32 v65, s33, v22
    v_lshlrev_b32 v66, 16, v23
    v_and_b32 v67, s33, v23
    v_lshlrev_b32 v68, 16, v24
    v_and_b32 v69, s33, v24
    v_lshlrev_b32 v70, 16, v25
    v_and_b32 v71, s33, v25
    v_pk_add_f32 v[32:33], v[32:33], v[52:53]
    v_pk_add_f32 v[34:35], v[34:35], v[54:55]
    v_pk_add_f32 v[36:37], v[36:37], v[56:57]
    v_pk_add_f32 v[38:39], v[38:39], v[58:59]
    v_pk_add_f32 v[40:41], v[40:41], v[60:61]
    v_pk_add_f32 v[42:43], v[42:43], v[62:63]
    v_pk_add_f32 v[44:45], v[44:45], v[64:65]
    v_pk_add_f32 v[46:47], v[46:47], v[66:67]
    v_pk_add_f32 v[48:49], v[48:49], v[68:69]
    v_pk_add_f32 v[50:51], v[50:51], v[70:71]
    v_cvt_pk_bf16_f32 v16, v32, v33
    v_cvt_pk_bf16_f32 v17, v34, v35
    v_cvt_pk_bf16_f32 v18, v36, v37
    v_cvt_pk_bf16_f32 v19, v38, v39
    v_cvt_pk_bf16_f32 v20, v40, v41
    v_cvt_pk_bf16_f32 v21, v42, v43
    v_cvt_pk_bf16_f32 v22, v44, v45
    v_cvt_pk_bf16_f32 v23, v46, v47
    v_cvt_pk_bf16_f32 v24, v48, v49
    v_cvt_pk_bf16_f32 v25, v50, v51
    s_waitcnt lgkmcnt(0)
    v_readfirstlane_b32 s63, v2
    s_nop 3
    s_cmp_eq_u32 s63, 1
    s_cbranch_scc1 L_dual_63_f
    buffer_store_dwordx4 v[16:19], v13, s[16:19], 0 offen sc1
    buffer_store_dwordx4 v[20:23], v13, s[16:19], 0 offen offset:512 sc1
    buffer_store_dwordx2 v[24:25], v14, s[16:19], 0 offen sc1
    s_branch L_dual_63_d
L_dual_63_f:
    buffer_store_dwordx4 v[16:19], v13, s[16:19], 0 offen
    buffer_store_dwordx4 v[20:23], v13, s[16:19], 0 offen offset:512
    buffer_store_dwordx2 v[24:25], v14, s[16:19], 0 offen
L_dual_63_d:
    v_pk_add_f32 v[52:53], v[32:33], v[34:35]
    v_pk_mul_f32 v[54:55], v[32:33], v[32:33]
    v_pk_fma_f32 v[54:55], v[34:35], v[34:35], v[54:55]
    v_pk_add_f32 v[52:53], v[52:53], v[36:37]
    v_pk_fma_f32 v[54:55], v[36:37], v[36:37], v[54:55]
    v_pk_add_f32 v[52:53], v[52:53], v[38:39]
    v_pk_fma_f32 v[54:55], v[38:39], v[38:39], v[54:55]
    v_pk_add_f32 v[52:53], v[52:53], v[40:41]
    v_pk_fma_f32 v[54:55], v[40:41], v[40:41], v[54:55]
    v_pk_add_f32 v[52:53], v[52:53], v[42:43]
    v_pk_fma_f32 v[54:55], v[42:43], v[42:43], v[54:55]
    v_pk_add_f32 v[52:53], v[52:53], v[44:45]
    v_pk_fma_f32 v[54:55], v[44:45], v[44:45], v[54:55]
    v_pk_add_f32 v[52:53], v[52:53], v[46:47]
    v_pk_fma_f32 v[54:55], v[46:47], v[46:47], v[54:55]
    v_pk_add_f32 v[52:53], v[52:53], v[48:49]
    v_pk_fma_f32 v[54:55], v[48:49], v[48:49], v[54:55]
    v_pk_add_f32 v[52:53], v[52:53], v[50:51]
    v_pk_fma_f32 v[54:55], v[50:51], v[50:51], v[54:55]
    v_add_f32 v52, v52, v53
    v_add_f32 v53, v54, v55
    v_mov_b32 v54, v52
    v_mov_b32 v55, v53
    s_nop 1
    v_permlane32_swap_b32 v52, v54
    v_permlane32_swap_b32 v53, v55
    s_nop 1
    v_pk_add_f32 v[52:53], v[52:53], v[54:55]
    v_mov_b32 v54, v52
    v_mov_b32 v55, v53
    s_nop 1
    v_permlane16_swap_b32 v52, v54
    v_permlane16_swap_b32 v53, v55
    s_nop 1
    v_pk_add_f32 v[52:53], v[52:53], v[54:55]
    s_lshl_b32 s32, s56, 10
    s_lshl_b32 s33, s57, 3
    s_add_u32 s32, s32, s33
    s_add_u32 s32, s32, 13107200
    v_lshlrev_b32 v7, 6, v15
    s_mov_b64 exec, 0xffff
    s_cmp_eq_u32 s63, 1
    s_cbranch_scc1 L_dual_64_f
    buffer_store_dwordx2 v[52:53], v7, s[16:19], s32 offen sc1
    s_branch L_dual_64_d
L_dual_64_f:
    buffer_store_dwordx2 v[52:53], v7, s[16:19], s32 offen
L_dual_64_d:
    s_mov_b64 exec, -1
    s_barrier
    s_lshl_b32 s58, s52, 1
    s_and_b32 s31, s53, 1
    s_add_u32 s58, s58, s31
    s_lshl_b32 s58, s58, 2
    s_add_u32 s58, s58, s24
    s_mul_i32 s55, s58, 40960
    s_add_u32 s55, s55, 10485760
    s_mov_b32 s38, s55
    s_add_u32 s39, s55, 40960
    s_lshl_b32 s31, s61, 10
    s_add_u32 s55, s55, s31
    s_mul_i32 s31, s58, 98304
    s_mul_i32 s33, s59, 3072
    s_add_u32 s31, s31, s33
    s_add_u32 s31, s31, 13631488
    v_bfe_u32 v3, v1, 4, 1
    v_mul_u32_u24 v3, 49152, v3
    v_lshrrev_b32 v4, 5, v1
    v_lshl_add_u32 v3, v4, 8, v3
    v_lshl_add_u32 v3, v15, 4, v3
    v_add_u32 v28, s31, v3
    v_and_b32 v5, 31, v1
    v_lshlrev_b32 v5, 6, v5
    v_lshl_add_u32 v29, v4, 5, v5
    v_lshlrev_b32 v4, 4, v4
    v_add_u32 v30, 162816, v4
    s_lshl_b32 s32, s56, 5
    s_lshl_b32 s33, s57, 2
    s_add_u32 s32, s32, s33
    s_add_u32 s32, s32, 26230784
    s_cmp_eq_u32 s63, 1
    s_cbranch_scc1 L_dual_65_f
    v_mov_b32 v2, 0
    v_mov_b32 v3, 1
    s_waitcnt vmcnt(0)
    s_mov_b64 exec, 1
    buffer_store_dword v3, v2, s[16:19], s32 offen sc1
    s_mov_b64 exec, -1
    s_mov_b32 exec_lo, 0x01010101
    s_mov_b32 exec_hi, 0x01010101
    buffer_load_dword v2, v13, s[16:19], 0 offen
    buffer_load_dword v3, v13, s[16:19], 0 offen offset:512
    buffer_load_dword v4, v14, s[16:19], 0 offen
    s_mov_b64 exec, -1
    s_branch L_dual_65_d
L_dual_65_f:
    v_mov_b32 v2, 0
    v_mov_b32 v3, 1
    s_waitcnt vmcnt(0)
    s_mov_b64 exec, 1
    buffer_store_dword v3, v2, s[16:19], s32 offen
    s_mov_b64 exec, -1
L_dual_65_d:
    v_mov_b32 v32, 0
    v_mov_b32 v33, 0
    v_mov_b32 v34, 0
    v_mov_b32 v35, 0
    v_mov_b32 v36, 0
    v_mov_b32 v37, 0
    v_mov_b32 v38, 0
    v_mov_b32 v39, 0
    v_mov_b32 v40, 0
    v_mov_b32 v41, 0
    v_mov_b32 v42, 0
    v_mov_b32 v43, 0
    v_mov_b32 v44, 0
    v_mov_b32 v45, 0
    v_mov_b32 v46, 0
    v_mov_b32 v47, 0
    v_mov_b32 v48, 0
    v_mov_b32 v49, 0
    v_mov_b32 v50, 0
    v_mov_b32 v51, 0
    v_mov_b32 v52, 0
    v_mov_b32 v53, 0
    v_mov_b32 v54, 0
    v_mov_b32 v55, 0
    v_mov_b32 v56, 0
    v_mov_b32 v57, 0
    v_mov_b32 v58, 0
    v_mov_b32 v59, 0
    v_mov_b32 v60, 0
    v_mov_b32 v61, 0
    v_mov_b32 v62, 0
    v_mov_b32 v63, 0
    v_mov_b32 v64, 0
    v_mov_b32 v65, 0
    v_mov_b32 v66, 0
    v_mov_b32 v67, 0
    v_mov_b32 v68, 0
    v_mov_b32 v69, 0
    v_mov_b32 v70, 0
    v_mov_b32 v71, 0
    v_mov_b32 v72, 0
    v_mov_b32 v73, 0
    v_mov_b32 v74, 0
    v_mov_b32 v75, 0
    v_mov_b32 v76, 0
    v_mov_b32 v77, 0
    v_mov_b32 v78, 0
    v_mov_b32 v79, 0
    s_lshl_b32 s32, s58, 11
    s_add_u32 s32, s32, 13107200
    s_barrier
    buffer_load_dwordx4 v[116:119], v8, s[16:19], s55 offen offset:0 sc1
    buffer_load_dwordx4 v[120:123], v8, s[16:19], s55 offen offset:1024 sc1
    buffer_load_dwordx4 v[124:127], v8, s[16:19], s55 offen offset:2048 sc1
    buffer_load_dwordx4 v[128:131], v8, s[16:19], s55 offen offset:3072 sc1
    s_add_u32 s55, s55, 4096
    s_cmp_eq_u32 s55, s39
    s_cmov_b32 s55, s38
    buffer_load_dwordx4 v[132:135], v8, s[16:19], s55 offen offset:0 sc1
    buffer_load_dwordx4 v[136:139], v8, s[16:19], s55 offen offset:1024 sc1
    buffer_load_dwordx4 v[140:143], v8, s[16:19], s55 offen offset:2048 sc1
    buffer_load_dwordx4 v[144:147], v8, s[16:19], s55 offen offset:3072 sc1
    s_add_u32 s55, s55, 4096
    s_cmp_eq_u32 s55, s39
    s_cmov_b32 s55, s38
    buffer_load_dwordx4 v[148:151], v8, s[16:19], s55 offen offset:0 sc1
    buffer_load_dwordx4 v[152:155], v8, s[16:19], s55 offen offset:1024 sc1
    ds_read_b128 v[80:83], v10 offset:6144
    ds_read_b128 v[84:87], v10 offset:7168
    ds_read_b128 v[88:91], v10 offset:8192
    ds_read_b128 v[92:95], v10 offset:9216
    ds_read_b128 v[96:99], v10 offset:10240
    ds_read_b128 v[100:103], v10 offset:11264
    s_waitcnt vmcnt(9) lgkmcnt(3)
    v_mfma_f32_32x32x16_bf16 v[32:47], v[80:83], v[116:119], v[32:47]
    ds_read_b128 v[104:107], v10 offset:12288
    v_mfma_f32_32x32x16_bf16 v[48:63], v[84:87], v[116:119], v[48:63]
    ds_read_b128 v[108:111], v10 offset:13312
    v_mfma_f32_32x32x16_bf16 v[64:79], v[88:91], v[116:119], v[64:79]
    ds_read_b128 v[112:115], v10 offset:14336
    buffer_load_dwordx4 v[156:159], v8, s[16:19], s55 offen offset:2048 sc1
    s_waitcnt vmcnt(9) lgkmcnt(3)
    v_mfma_f32_32x32x16_bf16 v[32:47], v[92:95], v[120:123], v[32:47]
    ds_read_b128 v[80:83], v11 offset:12288
    v_mfma_f32_32x32x16_bf16 v[48:63], v[96:99], v[120:123], v[48:63]
    ds_read_b128 v[84:87], v11 offset:13312
    v_mfma_f32_32x32x16_bf16 v[64:79], v[100:103], v[120:123], v[64:79]
    ds_read_b128 v[88:91], v11 offset:14336
    buffer_load_dwordx4 v[116:119], v8, s[16:19], s55 offen offset:3072 sc1
    s_add_u32 s55, s55, 4096
    s_cmp_eq_u32 s55, s39
    s_cmov_b32 s55, s38
    s_waitcnt vmcnt(9) lgkmcnt(3)
    v_mfma_f32_32x32x16_bf16 v[32:47], v[104:107], v[124:127], v[32:47]
    ds_read_b128 v[92:95], v11 offset:15360
    v_mfma_f32_32x32x16_bf16 v[48:63], v[108:111], v[124:127], v[48:63]
    ds_read_b128 v[96:99], v11 offset:16384
    v_mfma_f32_32x32x16_bf16 v[64:79], v[112:115], v[124:127], v[64:79]
    ds_read_b128 v[100:103], v11 offset:17408
    buffer_load_dwordx4 v[120:123], v8, s[16:19], s55 offen offset:0 sc1
    s_waitcnt vmcnt(9) lgkmcnt(3)
    v_mfma_f32_32x32x16_bf16 v[32:47], v[80:83], v[128:131], v[32:47]
    ds_read_b128 v[104:107], v11 offset:18432
    v_mfma_f32_32x32x16_bf16 v[48:63], v[84:87], v[128:131], v[48:63]
    ds_read_b128 v[108:111], v11 offset:19456
    v_mfma_f32_32x32x16_bf16 v[64:79], v[88:91], v[128:131], v[64:79]
    ds_read_b128 v[112:115], v11 offset:20480
    buffer_load_dwordx4 v[124:127], v8, s[16:19], s55 offen offset:1024 sc1
    s_waitcnt vmcnt(9) lgkmcnt(3)
    v_mfma_f32_32x32x16_bf16 v[32:47], v[92:95], v[132:135], v[32:47]
    ds_read_b128 v[80:83], v11 offset:21504
    v_mfma_f32_32x32x16_bf16 v[48:63], v[96:99], v[132:135], v[48:63]
    ds_read_b128 v[84:87], v11 offset:22528
    v_mfma_f32_32x32x16_bf16 v[64:79], v[100:103], v[132:135], v[64:79]
    ds_read_b128 v[88:91], v11 offset:23552
    buffer_load_dwordx4 v[128:131], v8, s[16:19], s55 offen offset:2048 sc1
    s_waitcnt vmcnt(9) lgkmcnt(3)
    v_mfma_f32_32x32x16_bf16 v[32:47], v[104:107], v[136:139], v[32:47]
    ds_read_b128 v[92:95], v11 offset:24576
    v_mfma_f32_32x32x16_bf16 v[48:63], v[108:111], v[136:139], v[48:63]
    ds_read_b128 v[96:99], v11 offset:25600
    v_mfma_f32_32x32x16_bf16 v[64:79], v[112:115], v[136:139], v[64:79]
    ds_read_b128 v[100:103], v11 offset:26624
    buffer_load_dwordx4 v[132:135], v8, s[16:19], s55 offen offset:3072 sc1
    s_add_u32 s55, s55, 4096
    s_cmp_eq_u32 s55, s39
    s_cmov_b32 s55, s38
    s_waitcnt vmcnt(9) lgkmcnt(3)
    v_mfma_f32_32x32x16_bf16 v[32:47], v[80:83], v[140:143], v[32:47]
    ds_read_b128 v[104:107], v11 offset:27648
    v_mfma_f32_32x32x16_bf16 v[48:63], v[84:87], v[140:143], v[48:63]
    ds_read_b128 v[108:111], v11 offset:28672
    v_mfma_f32_32x32x16_bf16 v[64:79], v[88:91], v[140:143], v[64:79]
    ds_read_b128 v[112:115], v11 offset:29696
    buffer_load_dwordx4 v[136:139], v8, s[16:19], s55 offen offset:0 sc1
    s_waitcnt vmcnt(9) lgkmcnt(3)
    v_mfma_f32_32x32x16_bf16 v[32:47], v[92:95], v[144:147], v[32:47]
    ds_read_b128 v[80:83], v9 offset:0
    v_mfma_f32_32x32x16_bf16 v[48:63], v[96:99], v[144:147], v[48:63]
    ds_read_b128 v[84:87], v9 offset:1024
    v_mfma_f32_32x32x16_bf16 v[64:79], v[100:103], v[144:147], v[64:79]
    ds_read_b128 v[88:91], v9 offset:2048
    buffer_load_dwordx4 v[140:143], v8, s[16:19], s55 offen offset:1024 sc1
    s_waitcnt vmcnt(9) lgkmcnt(3)
    v_mfma_f32_32x32x16_bf16 v[32:47], v[104:107], v[148:151], v[32:47]
    ds_read_b128 v[92:95], v9 offset:3072
    v_mfma_f32_32x32x16_bf16 v[48:63], v[108:111], v[148:151], v[48:63]
    ds_read_b128 v[96:99], v9 offset:4096
    v_mfma_f32_32x32x16_bf16 v[64:79], v[112:115], v[148:151], v[64:79]
    ds_read_b128 v[100:103], v9 offset:5120
    buffer_load_dwordx4 v[144:147], v8, s[16:19], s55 offen offset:2048 sc1
    s_waitcnt vmcnt(9) lgkmcnt(3)
    v_mfma_f32_32x32x16_bf16 v[32:47], v[80:83], v[152:155], v[32:47]
    ds_read_b128 v[104:107], v9 offset:6144
    v_mfma_f32_32x32x16_bf16 v[48:63], v[84:87], v[152:155], v[48:63]
    ds_read_b128 v[108:111], v9 offset:7168
    v_mfma_f32_32x32x16_bf16 v[64:79], v[88:91], v[152:155], v[64:79]
    ds_read_b128 v[112:115], v9 offset:8192
    buffer_load_dwordx4 v[148:151], v8, s[16:19], s55 offen offset:3072 sc1
    s_add_u32 s55, s55, 4096
    s_cmp_eq_u32 s55, s39
    s_cmov_b32 s55, s38
    s_waitcnt vmcnt(9) lgkmcnt(3)
    v_mfma_f32_32x32x16_bf16 v[32:47], v[92:95], v[156:159], v[32:47]
    ds_read_b128 v[80:83], v9 offset:9216
    v_mfma_f32_32x32x16_bf16 v[48:63], v[96:99], v[156:159], v[48:63]
    ds_read_b128 v[84:87], v9 offset:10240
    v_mfma_f32_32x32x16_bf16 v[64:79], v[100:103], v[156:159], v[64:79]
    ds_read_b128 v[88:91], v9 offset:11264
    buffer_load_dwordx4 v[152:155], v8, s[16:19], s55 offen offset:0 sc1
    s_waitcnt vmcnt(9) lgkmcnt(3)
    v_mfma_f32_32x32x16_bf16 v[32:47], v[104:107], v[116:119], v[32:47]
    ds_read_b128 v[92:95], v9 offset:12288
    v_mfma_f32_32x32x16_bf16 v[48:63], v[108:111], v[116:119], v[48:63]
    ds_read_b128 v[96:99], v9 offset:13312
    v_mfma_f32_32x32x16_bf16 v[64:79], v[112:115], v[116:119], v[64:79]
    ds_read_b128 v[100:103], v9 offset:14336
    buffer_load_dwordx4 v[156:159], v8, s[16:19], s55 offen offset:1024 sc1
    s_waitcnt vmcnt(9) lgkmcnt(3)
    v_mfma_f32_32x32x16_bf16 v[32:47], v[80:83], v[120:123], v[32:47]
    ds_read_b128 v[104:107], v9 offset:15360
    v_mfma_f32_32x32x16_bf16 v[48:63], v[84:87], v[120:123], v[48:63]
    ds_read_b128 v[108:111], v9 offset:16384
    v_mfma_f32_32x32x16_bf16 v[64:79], v[88:91], v[120:123], v[64:79]
    ds_read_b128 v[112:115], v9 offset:17408
    buffer_load_dwordx4 v[116:119], v8, s[16:19], s55 offen offset:2048 sc1
    s_waitcnt vmcnt(9) lgkmcnt(3)
    v_mfma_f32_32x32x16_bf16 v[32:47], v[92:95], v[124:127], v[32:47]
    ds_read_b128 v[80:83], v9 offset:18432
    v_mfma_f32_32x32x16_bf16 v[48:63], v[96:99], v[124:127], v[48:63]
    ds_read_b128 v[84:87], v9 offset:19456
    v_mfma_f32_32x32x16_bf16 v[64:79], v[100:103], v[124:127], v[64:79]
    ds_read_b128 v[88:91], v9 offset:20480
    buffer_load_dwordx4 v[120:123], v8, s[16:19], s55 offen offset:3072 sc1
    s_add_u32 s55, s55, 4096
    s_cmp_eq_u32 s55, s39
    s_cmov_b32 s55, s38
    s_waitcnt vmcnt(9) lgkmcnt(3)
    v_mfma_f32_32x32x16_bf16 v[32:47], v[104:107], v[128:131], v[32:47]
    ds_read_b128 v[92:95], v9 offset:21504
    v_mfma_f32_32x32x16_bf16 v[48:63], v[108:111], v[128:131], v[48:63]
    ds_read_b128 v[96:99], v9 offset:22528
    v_mfma_f32_32x32x16_bf16 v[64:79], v[112:115], v[128:131], v[64:79]
    ds_read_b128 v[100:103], v9 offset:23552
    buffer_load_dwordx4 v[124:127], v8, s[16:19], s55 offen offset:0 sc1
    s_waitcnt vmcnt(9) lgkmcnt(3)
    v_mfma_f32_32x32x16_bf16 v[32:47], v[80:83], v[132:135], v[32:47]
    ds_read_b128 v[104:107], v9 offset:24576
    v_mfma_f32_32x32x16_bf16 v[48:63], v[84:87], v[132:135], v[48:63]
    ds_read_b128 v[108:111], v9 offset:25600
    v_mfma_f32_32x32x16_bf16 v[64:79], v[88:91], v[132:135], v[64:79]
    ds_read_b128 v[112:115], v9 offset:26624
    buffer_load_dwordx4 v[128:131], v8, s[16:19], s55 offen offset:1024 sc1
    s_waitcnt vmcnt(9) lgkmcnt(3)
    v_mfma_f32_32x32x16_bf16 v[32:47], v[92:95], v[136:139], v[32:47]
    ds_read_b128 v[80:83], v9 offset:27648
    v_mfma_f32_32x32x16_bf16 v[48:63], v[96:99], v[136:139], v[48:63]
    ds_read_b128 v[84:87], v9 offset:28672
    v_mfma_f32_32x32x16_bf16 v[64:79], v[100:103], v[136:139], v[64:79]
    ds_read_b128 v[88:91], v9 offset:29696
    buffer_load_dwordx4 v[132:135], v8, s[16:19], s55 offen offset:2048 sc1
    s_waitcnt vmcnt(9) lgkmcnt(3)
    v_mfma_f32_32x32x16_bf16 v[32:47], v[104:107], v[140:143], v[32:47]
    ds_read_b128 v[92:95], v9 offset:30720
    v_mfma_f32_32x32x16_bf16 v[48:63], v[108:111], v[140:143], v[48:63]
    ds_read_b128 v[96:99], v9 offset:31744
    v_mfma_f32_32x32x16_bf16 v[64:79], v[112:115], v[140:143], v[64:79]
    ds_read_b128 v[100:103], v9 offset:32768
    buffer_load_dwordx4 v[136:139], v8, s[16:19], s55 offen offset:3072 sc1
    s_add_u32 s55, s55, 4096
    s_cmp_eq_u32 s55, s39
    s_cmov_b32 s55, s38
    s_waitcnt vmcnt(9) lgkmcnt(3)
    s_barrier
    v_mfma_f32_32x32x16_bf16 v[32:47], v[80:83], v[144:147], v[32:47]
    ds_read_b128 v[104:107], v9 offset:33792
    v_mfma_f32_32x32x16_bf16 v[48:63], v[84:87], v[144:147], v[48:63]
    ds_read_b128 v[108:111], v9 offset:34816
    v_mfma_f32_32x32x16_bf16 v[64:79], v[88:91], v[144:147], v[64:79]
    ds_read_b128 v[112:115], v9 offset:35840
    buffer_load_dwordx4 v[140:143], v8, s[16:19], s55 offen offset:0 sc1
    s_waitcnt vmcnt(9) lgkmcnt(3)
    v_mfma_f32_32x32x16_bf16 v[32:47], v[92:95], v[148:151], v[32:47]
    ds_read_b128 v[80:83], v9 offset:36864
    v_mfma_f32_32x32x16_bf16 v[48:63], v[96:99], v[148:151], v[48:63]
    ds_read_b128 v[84:87], v9 offset:37888
    v_mfma_f32_32x32x16_bf16 v[64:79], v[100:103], v[148:151], v[64:79]
    ds_read_b128 v[88:91], v9 offset:38912
    buffer_load_dwordx4 v[144:147], v8, s[16:19], s55 offen offset:1024 sc1
    s_waitcnt vmcnt(9) lgkmcnt(3)
    v_mfma_f32_32x32x16_bf16 v[32:47], v[104:107], v[152:155], v[32:47]
    ds_read_b128 v[92:95], v9 offset:39936
    v_mfma_f32_32x32x16_bf16 v[48:63], v[108:111], v[152:155], v[48:63]
    ds_read_b128 v[96:99], v9 offset:40960
    v_mfma_f32_32x32x16_bf16 v[64:79], v[112:115], v[152:155], v[64:79]
    ds_read_b128 v[100:103], v9 offset:41984
    buffer_load_dwordx4 v[148:151], v8, s[16:19], s55 offen offset:2048 sc1
    s_waitcnt vmcnt(9) lgkmcnt(3)
    v_mfma_f32_32x32x16_bf16 v[32:47], v[80:83], v[156:159], v[32:47]
    ds_read_b128 v[104:107], v9 offset:43008
    v_mfma_f32_32x32x16_bf16 v[48:63], v[84:87], v[156:159], v[48:63]
    ds_read_b128 v[108:111], v9 offset:44032
    v_mfma_f32_32x32x16_bf16 v[64:79], v[88:91], v[156:159], v[64:79]
    ds_read_b128 v[112:115], v9 offset:45056
    buffer_load_dwordx4 v[152:155], v8, s[16:19], s55 offen offset:3072 sc1
    s_add_u32 s55, s55, 4096
    s_cmp_eq_u32 s55, s39
    s_cmov_b32 s55, s38
    s_waitcnt vmcnt(9) lgkmcnt(3)
    v_mfma_f32_32x32x16_bf16 v[32:47], v[92:95], v[116:119], v[32:47]
    ds_read_b128 v[80:83], v9 offset:46080
    v_mfma_f32_32x32x16_bf16 v[48:63], v[96:99], v[116:119], v[48:63]
    ds_read_b128 v[84:87], v9 offset:47104
    v_mfma_f32_32x32x16_bf16 v[64:79], v[100:103], v[116:119], v[64:79]
    ds_read_b128 v[88:91], v9 offset:48128
    buffer_load_dwordx4 v[156:159], v8, s[16:19], s55 offen offset:0 sc1
    s_waitcnt vmcnt(9) lgkmcnt(3)
    v_mfma_f32_32x32x16_bf16 v[32:47], v[104:107], v[120:123], v[32:47]
    ds_read_b128 v[92:95], v9 offset:49152
    v_mfma_f32_32x32x16_bf16 v[48:63], v[108:111], v[120:123], v[48:63]
    ds_read_b128 v[96:99], v9 offset:50176
    v_mfma_f32_32x32x16_bf16 v[64:79], v[112:115], v[120:123], v[64:79]
    ds_read_b128 v[100:103], v9 offset:51200
    buffer_load_dwordx4 v[116:119], v8, s[16:19], s55 offen offset:1024 sc1
    s_waitcnt vmcnt(9) lgkmcnt(3)
    v_mfma_f32_32x32x16_bf16 v[32:47], v[80:83], v[124:127], v[32:47]
    ds_read_b128 v[104:107], v9 offset:52224
    v_mfma_f32_32x32x16_bf16 v[48:63], v[84:87], v[124:127], v[48:63]
    ds_read_b128 v[108:111], v9 offset:53248
    v_mfma_f32_32x32x16_bf16 v[64:79], v[88:91], v[124:127], v[64:79]
    ds_read_b128 v[112:115], v9 offset:54272
    buffer_load_dwordx4 v[120:123], v8, s[16:19], s55 offen offset:2048 sc1
    s_waitcnt vmcnt(9) lgkmcnt(3)
    v_mfma_f32_32x32x16_bf16 v[32:47], v[92:95], v[128:131], v[32:47]
    ds_read_b128 v[80:83], v9 offset:55296
    v_mfma_f32_32x32x16_bf16 v[48:63], v[96:99], v[128:131], v[48:63]
    ds_read_b128 v[84:87], v9 offset:56320
    v_mfma_f32_32x32x16_bf16 v[64:79], v[100:103], v[128:131], v[64:79]
    ds_read_b128 v[88:91], v9 offset:57344
    buffer_load_dwordx4 v[124:127], v8, s[16:19], s55 offen offset:3072 sc1
    s_add_u32 s55, s55, 4096
    s_cmp_eq_u32 s55, s39
    s_cmov_b32 s55, s38
    s_waitcnt vmcnt(9) lgkmcnt(3)
    v_mfma_f32_32x32x16_bf16 v[32:47], v[104:107], v[132:135], v[32:47]
    ds_read_b128 v[92:95], v9 offset:58368
    v_mfma_f32_32x32x16_bf16 v[48:63], v[108:111], v[132:135], v[48:63]
    ds_read_b128 v[96:99], v9 offset:59392
    v_mfma_f32_32x32x16_bf16 v[64:79], v[112:115], v[132:135], v[64:79]
    ds_read_b128 v[100:103], v9 offset:60416
    buffer_load_dwordx4 v[128:131], v8, s[16:19], s55 offen offset:0 sc1
    s_waitcnt vmcnt(9) lgkmcnt(3)
    v_mfma_f32_32x32x16_bf16 v[32:47], v[80:83], v[136:139], v[32:47]
    ds_read_b128 v[104:107], v10 offset:16384
    v_mfma_f32_32x32x16_bf16 v[48:63], v[84:87], v[136:139], v[48:63]
    ds_read_b128 v[108:111], v10 offset:17408
    v_mfma_f32_32x32x16_bf16 v[64:79], v[88:91], v[136:139], v[64:79]
    ds_read_b128 v[112:115], v10 offset:18432
    buffer_load_dwordx4 v[132:135], v8, s[16:19], s55 offen offset:1024 sc1
    s_waitcnt vmcnt(9) lgkmcnt(3)
    v_mfma_f32_32x32x16_bf16 v[32:47], v[92:95], v[140:143], v[32:47]
    ds_read_b128 v[80:83], v10 offset:19456
    v_mfma_f32_32x32x16_bf16 v[48:63], v[96:99], v[140:143], v[48:63]
    ds_read_b128 v[84:87], v10 offset:20480
    v_mfma_f32_32x32x16_bf16 v[64:79], v[100:103], v[140:143], v[64:79]
    ds_read_b128 v[88:91], v10 offset:21504
    buffer_load_dwordx4 v[136:139], v8, s[16:19], s55 offen offset:2048 sc1
    s_waitcnt vmcnt(9) lgkmcnt(3)
    v_mfma_f32_32x32x16_bf16 v[32:47], v[104:107], v[144:147], v[32:47]
    ds_read_b128 v[92:95], v10 offset:22528
    v_mfma_f32_32x32x16_bf16 v[48:63], v[108:111], v[144:147], v[48:63]
    ds_read_b128 v[96:99], v10 offset:23552
    v_mfma_f32_32x32x16_bf16 v[64:79], v[112:115], v[144:147], v[64:79]
    ds_read_b128 v[100:103], v10 offset:24576
    buffer_load_dwordx4 v[140:143], v8, s[16:19], s55 offen offset:3072 sc1
    s_add_u32 s55, s55, 4096
    s_cmp_eq_u32 s55, s39
    s_cmov_b32 s55, s38
    s_waitcnt vmcnt(9) lgkmcnt(3)
    v_mfma_f32_32x32x16_bf16 v[32:47], v[80:83], v[148:151], v[32:47]
    ds_read_b128 v[104:107], v10 offset:25600
    v_mfma_f32_32x32x16_bf16 v[48:63], v[84:87], v[148:151], v[48:63]
    ds_read_b128 v[108:111], v10 offset:26624
    v_mfma_f32_32x32x16_bf16 v[64:79], v[88:91], v[148:151], v[64:79]
    ds_read_b128 v[112:115], v10 offset:27648
    buffer_load_dwordx4 v[160:163], v29, s[16:19], s32 offen sc1
    buffer_load_dwordx4 v[164:167], v29, s[16:19], s32 offen offset:16 sc1
    s_waitcnt vmcnt(10) lgkmcnt(3)
    v_mfma_f32_32x32x16_bf16 v[32:47], v[92:95], v[152:155], v[32:47]
    ds_read_b128 v[80:83], v10 offset:28672
    v_mfma_f32_32x32x16_bf16 v[48:63], v[96:99], v[152:155], v[48:63]
    ds_read_b128 v[84:87], v10 offset:29696
    v_mfma_f32_32x32x16_bf16 v[64:79], v[100:103], v[152:155], v[64:79]
    ds_read_b128 v[88:91], v10 offset:30720
    s_waitcnt vmcnt(9) lgkmcnt(3)
    v_mfma_f32_32x32x16_bf16 v[32:47], v[104:107], v[156:159], v[32:47]
    ds_read_b128 v[92:95], v10 offset:31744
    v_mfma_f32_32x32x16_bf16 v[48:63], v[108:111], v[156:159], v[48:63]
    ds_read_b128 v[96:99], v10 offset:32768
    v_mfma_f32_32x32x16_bf16 v[64:79], v[112:115], v[156:159], v[64:79]
    ds_read_b128 v[100:103], v10 offset:33792
    s_waitcnt vmcnt(8) lgkmcnt(3)
    v_mfma_f32_32x32x16_bf16 v[32:47], v[80:83], v[116:119], v[32:47]
    ds_read_b128 v[104:107], v10 offset:34816
    v_mfma_f32_32x32x16_bf16 v[48:63], v[84:87], v[116:119], v[48:63]
    ds_read_b128 v[108:111], v10 offset:35840
    v_mfma_f32_32x32x16_bf16 v[64:79], v[88:91], v[116:119], v[64:79]
    ds_read_b128 v[112:115], v10 offset:36864
    s_waitcnt vmcnt(7) lgkmcnt(3)
    v_mfma_f32_32x32x16_bf16 v[32:47], v[92:95], v[120:123], v[32:47]
    ds_read_b128 v[80:83], v10 offset:37888
    v_mfma_f32_32x32x16_bf16 v[48:63], v[96:99], v[120:123], v[48:63]
    ds_read_b128 v[84:87], v10 offset:38912
    v_mfma_f32_32x32x16_bf16 v[64:79], v[100:103], v[120:123], v[64:79]
    ds_read_b128 v[88:91], v10 offset:39936
    s_waitcnt vmcnt(6) lgkmcnt(3)
    v_mfma_f32_32x32x16_bf16 v[32:47], v[104:107], v[124:127], v[32:47]
    ds_read_b128 v[92:95], v10 offset:40960
    v_mfma_f32_32x32x16_bf16 v[48:63], v[108:111], v[124:127], v[48:63]
    ds_read_b128 v[96:99], v10 offset:41984
    v_mfma_f32_32x32x16_bf16 v[64:79], v[112:115], v[124:127], v[64:79]
    ds_read_b128 v[100:103], v10 offset:43008
    s_waitcnt vmcnt(5) lgkmcnt(3)
    v_mfma_f32_32x32x16_bf16 v[32:47], v[80:83], v[128:131], v[32:47]
    ds_read_b128 v[104:107], v10 offset:44032
    v_mfma_f32_32x32x16_bf16 v[48:63], v[84:87], v[128:131], v[48:63]
    ds_read_b128 v[108:111], v10 offset:45056
    v_mfma_f32_32x32x16_bf16 v[64:79], v[88:91], v[128:131], v[64:79]
    ds_read_b128 v[112:115], v10 offset:46080
    s_waitcnt vmcnt(4) lgkmcnt(3)
    v_mfma_f32_32x32x16_bf16 v[32:47], v[92:95], v[132:135], v[32:47]
    ds_read_b128 v[80:83], v10 offset:47104
    v_mfma_f32_32x32x16_bf16 v[48:63], v[96:99], v[132:135], v[48:63]
    ds_read_b128 v[84:87], v10 offset:48128
    v_mfma_f32_32x32x16_bf16 v[64:79], v[100:103], v[132:135], v[64:79]
    ds_read_b128 v[88:91], v10 offset:49152
    s_waitcnt vmcnt(3) lgkmcnt(3)
    v_mfma_f32_32x32x16_bf16 v[32:47], v[104:107], v[136:139], v[32:47]
    v_mfma_f32_32x32x16_bf16 v[48:63], v[108:111], v[136:139], v[48:63]
    v_mfma_f32_32x32x16_bf16 v[64:79], v[112:115], v[136:139], v[64:79]
    s_waitcnt vmcnt(2) lgkmcnt(0)
    v_mfma_f32_32x32x16_bf16 v[32:47], v[80:83], v[140:143], v[32:47]
    v_mfma_f32_32x32x16_bf16 v[48:63], v[84:87], v[140:143], v[48:63]
    v_mfma_f32_32x32x16_bf16 v[64:79], v[88:91], v[140:143], v[64:79]
    ds_read_b128 v[80:83], v30 offset:0
    ds_read_b128 v[84:87], v30 offset:32
    ds_read_b128 v[88:91], v30 offset:64
    ds_read_b128 v[92:95], v30 offset:96
    ds_read_b128 v[96:99], v30 offset:128
    ds_read_b128 v[100:103], v30 offset:160
    ds_read_b128 v[104:107], v30 offset:192
    ds_read_b128 v[108:111], v30 offset:224
    ds_read_b128 v[112:115], v30 offset:256
    ds_read_b128 v[116:119], v30 offset:288
    ds_read_b128 v[120:123], v30 offset:320
    ds_read_b128 v[124:127], v30 offset:352
    s_waitcnt vmcnt(0)
    v_add_f32 v160, v160, v162
    v_add_f32 v161, v161, v163
    v_add_f32 v160, v160, v164
    v_add_f32 v161, v161, v165
    v_add_f32 v160, v160, v166
    v_add_f32 v161, v161, v167
    v_mov_b32 v162, v160
    v_mov_b32 v163, v161
    s_nop 1
    v_permlane32_swap_b32 v160, v162
    v_permlane32_swap_b32 v161, v163
    s_nop 1
    v_add_f32 v160, v160, v162
    v_add_f32 v161, v161, v163
    v_mul_f32 v26, 0x3acccccd, v160
    v_mul_f32 v2, 0x3acccccd, v161
    v_fma_f32 v2, -v26, v26, v2
    v_max_f32 v2, 0, v2
    v_cvt_pk_bf16_f32 v26, v26, v26
    v_lshlrev_b32 v26, 16, v26
    v_cvt_pk_bf16_f32 v2, v2, v2
    v_lshlrev_b32 v2, 16, v2
    v_add_f32 v2, 0x3727c5ac, v2
    v_cvt_pk_bf16_f32 v2, v2, v2
    v_lshlrev_b32 v2, 16, v2
    v_sqrt_f32 v2, v2
    s_nop 0
    v_cvt_pk_bf16_f32 v2, v2, v2
    v_lshlrev_b32 v2, 16, v2
    v_rcp_f32 v27, v2
    s_nop 0
    s_waitcnt lgkmcnt(8)
    v_pk_fma_f32 v[32:33], v[80:81], v[26:27], v[32:33] op_sel:[0,0,0] op_sel_hi:[1,0,1] neg_lo:[0,1,0] neg_hi:[0,1,0]
    v_pk_fma_f32 v[34:35], v[82:83], v[26:27], v[34:35] op_sel:[0,0,0] op_sel_hi:[1,0,1] neg_lo:[0,1,0] neg_hi:[0,1,0]
    v_pk_fma_f32 v[36:37], v[84:85], v[26:27], v[36:37] op_sel:[0,0,0] op_sel_hi:[1,0,1] neg_lo:[0,1,0] neg_hi:[0,1,0]
    v_pk_fma_f32 v[38:39], v[86:87], v[26:27], v[38:39] op_sel:[0,0,0] op_sel_hi:[1,0,1] neg_lo:[0,1,0] neg_hi:[0,1,0]
    v_pk_mul_f32 v[32:33], v[32:33], v[26:27] op_sel:[0,1] op_sel_hi:[1,1]
    v_pk_mul_f32 v[34:35], v[34:35], v[26:27] op_sel:[0,1] op_sel_hi:[1,1]
    v_pk_mul_f32 v[36:37], v[36:37], v[26:27] op_sel:[0,1] op_sel_hi:[1,1]
    v_pk_mul_f32 v[38:39], v[38:39], v[26:27] op_sel:[0,1] op_sel_hi:[1,1]
    v_cvt_pk_bf16_f32 v32, v32, v33
    v_cvt_pk_bf16_f32 v33, v34, v35
    v_cvt_pk_bf16_f32 v34, v36, v37
    v_cvt_pk_bf16_f32 v35, v38, v39
    v_pk_max_i16 v32, v32, 0
    v_pk_max_i16 v33, v33, 0
    v_pk_max_i16 v34, v34, 0
    v_pk_max_i16 v35, v35, 0
    s_cmp_eq_u32 s63, 1
    s_cbranch_scc1 L_dual_66_f
    buffer_store_dwordx4 v[32:35], v28, s[16:19], 0 offen offset:0 sc1
    s_branch L_dual_66_d
L_dual_66_f:
    buffer_store_dwordx4 v[32:35], v28, s[16:19], 0 offen offset:0
L_dual_66_d:
    v_pk_fma_f32 v[40:41], v[88:89], v[26:27], v[40:41] op_sel:[0,0,0] op_sel_hi:[1,0,1] neg_lo:[0,1,0] neg_hi:[0,1,0]
    v_pk_fma_f32 v[42:43], v[90:91], v[26:27], v[42:43] op_sel:[0,0,0] op_sel_hi:[1,0,1] neg_lo:[0,1,0] neg_hi:[0,1,0]
    v_pk_fma_f32 v[44:45], v[92:93], v[26:27], v[44:45] op_sel:[0,0,0] op_sel_hi:[1,0,1] neg_lo:[0,1,0] neg_hi:[0,1,0]
    v_pk_fma_f32 v[46:47], v[94:95], v[26:27], v[46:47] op_sel:[0,0,0] op_sel_hi:[1,0,1] neg_lo:[0,1,0] neg_hi:[0,1,0]
    v_pk_mul_f32 v[40:41], v[40:41], v[26:27] op_sel:[0,1] op_sel_hi:[1,1]
    v_pk_mul_f32 v[42:43], v[42:43], v[26:27] op_sel:[0,1] op_sel_hi:[1,1]
    v_pk_mul_f32 v[44:45], v[44:45], v[26:27] op_sel:[0,1] op_sel_hi:[1,1]
    v_pk_mul_f32 v[46:47], v[46:47], v[26:27] op_sel:[0,1] op_sel_hi:[1,1]
    v_cvt_pk_bf16_f32 v40, v40, v41
    v_cvt_pk_bf16_f32 v41, v42, v43
    v_cvt_pk_bf16_f32 v42, v44, v45
    v_cvt_pk_bf16_f32 v43, v46, v47
    v_pk_max_i16 v40, v40, 0
    v_pk_max_i16 v41, v41, 0
    v_pk_max_i16 v42, v42, 0
    v_pk_max_i16 v43, v43, 0
    s_cmp_eq_u32 s63, 1
    s_cbranch_scc1 L_dual_67_f
    buffer_store_dwordx4 v[40:43], v28, s[16:19], 0 offen offset:512 sc1
    s_branch L_dual_67_d
L_dual_67_f:
    buffer_store_dwordx4 v[40:43], v28, s[16:19], 0 offen offset:512
L_dual_67_d:
    s_waitcnt lgkmcnt(4)
    v_pk_fma_f32 v[48:49], v[96:97], v[26:27], v[48:49] op_sel:[0,0,0] op_sel_hi:[1,0,1] neg_lo:[0,1,0] neg_hi:[0,1,0]
    v_pk_fma_f32 v[50:51], v[98:99], v[26:27], v[50:51] op_sel:[0,0,0] op_sel_hi:[1,0,1] neg_lo:[0,1,0] neg_hi:[0,1,0]
    v_pk_fma_f32 v[52:53], v[100:101], v[26:27], v[52:53] op_sel:[0,0,0] op_sel_hi:[1,0,1] neg_lo:[0,1,0] neg_hi:[0,1,0]
    v_pk_fma_f32 v[54:55], v[102:103], v[26:27], v[54:55] op_sel:[0,0,0] op_sel_hi:[1,0,1] neg_lo:[0,1,0] neg_hi:[0,1,0]
    v_pk_mul_f32 v[48:49], v[48:49], v[26:27] op_sel:[0,1] op_sel_hi:[1,1]
    v_pk_mul_f32 v[50:51], v[50:51], v[26:27] op_sel:[0,1] op_sel_hi:[1,1]
    v_pk_mul_f32 v[52:53], v[52:53], v[26:27] op_sel:[0,1] op_sel_hi:[1,1]
    v_pk_mul_f32 v[54:55], v[54:55], v[26:27] op_sel:[0,1] op_sel_hi:[1,1]
    v_cvt_pk_bf16_f32 v48, v48, v49
    v_cvt_pk_bf16_f32 v49, v50, v51
    v_cvt_pk_bf16_f32 v50, v52, v53
    v_cvt_pk_bf16_f32 v51, v54, v55
    v_pk_max_i16 v48, v48, 0
    v_pk_max_i16 v49, v49, 0
    v_pk_max_i16 v50, v50, 0
    v_pk_max_i16 v51, v51, 0
    s_cmp_eq_u32 s63, 1
    s_cbranch_scc1 L_dual_68_f
    buffer_store_dwordx4 v[48:51], v28, s[16:19], 0 offen offset:1024 sc1
    s_branch L_dual_68_d
L_dual_68_f:
    buffer_store_dwordx4 v[48:51], v28, s[16:19], 0 offen offset:1024
L_dual_68_d:
    v_pk_fma_f32 v[56:57], v[104:105], v[26:27], v[56:57] op_sel:[0,0,0] op_sel_hi:[1,0,1] neg_lo:[0,1,0] neg_hi:[0,1,0]
    v_pk_fma_f32 v[58:59], v[106:107], v[26:27], v[58:59] op_sel:[0,0,0] op_sel_hi:[1,0,1] neg_lo:[0,1,0] neg_hi:[0,1,0]
    v_pk_fma_f32 v[60:61], v[108:109], v[26:27], v[60:61] op_sel:[0,0,0] op_sel_hi:[1,0,1] neg_lo:[0,1,0] neg_hi:[0,1,0]
    v_pk_fma_f32 v[62:63], v[110:111], v[26:27], v[62:63] op_sel:[0,0,0] op_sel_hi:[1,0,1] neg_lo:[0,1,0] neg_hi:[0,1,0]
    v_pk_mul_f32 v[56:57], v[56:57], v[26:27] op_sel:[0,1] op_sel_hi:[1,1]
    v_pk_mul_f32 v[58:59], v[58:59], v[26:27] op_sel:[0,1] op_sel_hi:[1,1]
    v_pk_mul_f32 v[60:61], v[60:61], v[26:27] op_sel:[0,1] op_sel_hi:[1,1]
    v_pk_mul_f32 v[62:63], v[62:63], v[26:27] op_sel:[0,1] op_sel_hi:[1,1]
    v_cvt_pk_bf16_f32 v56, v56, v57
    v_cvt_pk_bf16_f32 v57, v58, v59
    v_cvt_pk_bf16_f32 v58, v60, v61
    v_cvt_pk_bf16_f32 v59, v62, v63
    v_pk_max_i16 v56, v56, 0
    v_pk_max_i16 v57, v57, 0
    v_pk_max_i16 v58, v58, 0
    v_pk_max_i16 v59, v59, 0
    s_cmp_eq_u32 s63, 1
    s_cbranch_scc1 L_dual_69_f
    buffer_store_dwordx4 v[56:59], v28, s[16:19], 0 offen offset:1536 sc1
    s_branch L_dual_69_d
L_dual_69_f:
    buffer_store_dwordx4 v[56:59], v28, s[16:19], 0 offen offset:1536
L_dual_69_d:
    s_waitcnt lgkmcnt(0)
    v_pk_fma_f32 v[64:65], v[112:113], v[26:27], v[64:65] op_sel:[0,0,0] op_sel_hi:[1,0,1] neg_lo:[0,1,0] neg_hi:[0,1,0]
    v_pk_fma_f32 v[66:67], v[114:115], v[26:27], v[66:67] op_sel:[0,0,0] op_sel_hi:[1,0,1] neg_lo:[0,1,0] neg_hi:[0,1,0]
    v_pk_fma_f32 v[68:69], v[116:117], v[26:27], v[68:69] op_sel:[0,0,0] op_sel_hi:[1,0,1] neg_lo:[0,1,0] neg_hi:[0,1,0]
    v_pk_fma_f32 v[70:71], v[118:119], v[26:27], v[70:71] op_sel:[0,0,0] op_sel_hi:[1,0,1] neg_lo:[0,1,0] neg_hi:[0,1,0]
    v_pk_mul_f32 v[64:65], v[64:65], v[26:27] op_sel:[0,1] op_sel_hi:[1,1]
    v_pk_mul_f32 v[66:67], v[66:67], v[26:27] op_sel:[0,1] op_sel_hi:[1,1]
    v_pk_mul_f32 v[68:69], v[68:69], v[26:27] op_sel:[0,1] op_sel_hi:[1,1]
    v_pk_mul_f32 v[70:71], v[70:71], v[26:27] op_sel:[0,1] op_sel_hi:[1,1]
    v_cvt_pk_bf16_f32 v64, v64, v65
    v_cvt_pk_bf16_f32 v65, v66, v67
    v_cvt_pk_bf16_f32 v66, v68, v69
    v_cvt_pk_bf16_f32 v67, v70, v71
    v_pk_max_i16 v64, v64, 0
    v_pk_max_i16 v65, v65, 0
    v_pk_max_i16 v66, v66, 0
    v_pk_max_i16 v67, v67, 0
    s_cmp_eq_u32 s63, 1
    s_cbranch_scc1 L_dual_70_f
    buffer_store_dwordx4 v[64:67], v28, s[16:19], 0 offen offset:2048 sc1
    s_branch L_dual_70_d
L_dual_70_f:
    buffer_store_dwordx4 v[64:67], v28, s[16:19], 0 offen offset:2048
L_dual_70_d:
    v_pk_fma_f32 v[72:73], v[120:121], v[26:27], v[72:73] op_sel:[0,0,0] op_sel_hi:[1,0,1] neg_lo:[0,1,0] neg_hi:[0,1,0]
    v_pk_fma_f32 v[74:75], v[122:123], v[26:27], v[74:75] op_sel:[0,0,0] op_sel_hi:[1,0,1] neg_lo:[0,1,0] neg_hi:[0,1,0]
    v_pk_fma_f32 v[76:77], v[124:125], v[26:27], v[76:77] op_sel:[0,0,0] op_sel_hi:[1,0,1] neg_lo:[0,1,0] neg_hi:[0,1,0]
    v_pk_fma_f32 v[78:79], v[126:127], v[26:27], v[78:79] op_sel:[0,0,0] op_sel_hi:[1,0,1] neg_lo:[0,1,0] neg_hi:[0,1,0]
    v_pk_mul_f32 v[72:73], v[72:73], v[26:27] op_sel:[0,1] op_sel_hi:[1,1]
    v_pk_mul_f32 v[74:75], v[74:75], v[26:27] op_sel:[0,1] op_sel_hi:[1,1]
    v_pk_mul_f32 v[76:77], v[76:77], v[26:27] op_sel:[0,1] op_sel_hi:[1,1]
    v_pk_mul_f32 v[78:79], v[78:79], v[26:27] op_sel:[0,1] op_sel_hi:[1,1]
    v_cvt_pk_bf16_f32 v72, v72, v73
    v_cvt_pk_bf16_f32 v73, v74, v75
    v_cvt_pk_bf16_f32 v74, v76, v77
    v_cvt_pk_bf16_f32 v75, v78, v79
    v_pk_max_i16 v72, v72, 0
    v_pk_max_i16 v73, v73, 0
    v_pk_max_i16 v74, v74, 0
    v_pk_max_i16 v75, v75, 0
    s_cmp_eq_u32 s63, 1
    s_cbranch_scc1 L_dual_71_f
    buffer_store_dwordx4 v[72:75], v28, s[16:19], 0 offen offset:2560 sc1
    s_branch L_dual_71_d
L_dual_71_f:
    buffer_store_dwordx4 v[72:75], v28, s[16:19], 0 offen offset:2560
L_dual_71_d:
    s_barrier
    s_lshl_b32 s32, s58, 6
    s_lshl_b32 s33, s59, 2
    s_add_u32 s32, s32, s33
    s_add_u32 s32, s32, 26238976
    s_mov_b32 s8, s46
    s_and_b32 s9, s47, 0xffff
    s_mov_b32 s10, 2621440
    s_mov_b32 s11, 0x20000
    s_cmp_eq_u32 s63, 1
    s_cbranch_scc1 L_dual_72_f
    v_mov_b32 v2, 0
    v_mov_b32 v3, 1
    s_waitcnt vmcnt(0)
    s_mov_b64 exec, 1
    buffer_store_dword v3, v2, s[16:19], s32 offen sc1
    s_mov_b64 exec, -1
    s_mov_b32 exec_lo, 0x01010101
    s_mov_b32 exec_hi, 0x01010101
    buffer_load_dword v2, v28, s[16:19], 0 offen offset:0
    buffer_load_dword v3, v28, s[16:19], 0 offen offset:512
    buffer_load_dword v4, v28, s[16:19], 0 offen offset:1024
    buffer_load_dword v5, v28, s[16:19], 0 offen offset:1536
    buffer_load_dword v2, v28, s[16:19], 0 offen offset:2048
    buffer_load_dword v3, v28, s[16:19], 0 offen offset:2560
    s_mov_b64 exec, -1
    s_branch L_dual_72_d
L_dual_72_f:
    v_mov_b32 v2, 0
    v_mov_b32 v3, 1
    s_waitcnt vmcnt(0)
    s_mov_b64 exec, 1
    buffer_store_dword v3, v2, s[16:19], s32 offen
    s_mov_b64 exec, -1
L_dual_72_d:
    s_mul_i32 s55, s56, 49152
    s_add_u32 s55, s55, 13631488
    v_mov_b32 v32, 0
    v_mov_b32 v33, 0
    v_mov_b32 v34, 0
    v_mov_b32 v35, 0
    v_mov_b32 v36, 0
    v_mov_b32 v37, 0
    v_mov_b32 v38, 0
    v_mov_b32 v39, 0
    v_mov_b32 v40, 0
    v_mov_b32 v41, 0
    v_mov_b32 v42, 0
    v_mov_b32 v43, 0
    v_mov_b32 v44, 0
    v_mov_b32 v45, 0
    v_mov_b32 v46, 0
    v_mov_b32 v47, 0
    v_mov_b32 v48, 0
    v_mov_b32 v49, 0
    v_mov_b32 v50, 0
    v_mov_b32 v51, 0
    s_barrier
    buffer_load_dwordx4 v[112:115], v8, s[16:19], s55 offen offset:0 sc1
    buffer_load_dwordx4 v[116:119], v8, s[16:19], s55 offen offset:2048 sc1
    s_add_u32 s55, s55, 4096
    buffer_load_dwordx4 v[120:123], v8, s[16:19], s55 offen offset:0 sc1
    buffer_load_dwordx4 v[124:127], v8, s[16:19], s55 offen offset:2048 sc1
    s_add_u32 s55, s55, 4096
    buffer_load_dwordx4 v[128:131], v8, s[16:19], s55 offen offset:0 sc1
    buffer_load_dwordx4 v[132:135], v8, s[16:19], s55 offen offset:2048 sc1
    s_add_u32 s55, s55, 4096
    buffer_load_dwordx4 v[136:139], v8, s[16:19], s55 offen offset:0 sc1
    buffer_load_dwordx4 v[140:143], v8, s[16:19], s55 offen offset:2048 sc1
    s_add_u32 s55, s55, 4096
    ds_read_b128 v[52:55], v10 offset:50176
    ds_read_b128 v[56:59], v10 offset:51200
    ds_read_b128 v[60:63], v10 offset:52224
    ds_read_b128 v[64:67], v10 offset:53248
    ds_read_b128 v[68:71], v10 offset:54272
    ds_read_b128 v[72:75], v10 offset:60416
    ds_read_b128 v[76:79], v10 offset:61440
    ds_read_b128 v[80:83], v10 offset:62464
    ds_read_b128 v[84:87], v10 offset:63488
    ds_read_b128 v[88:91], v10 offset:64512
    s_waitcnt vmcnt(7) lgkmcnt(5)
    v_mfma_f32_16x16x32_bf16 v[32:35], v[52:55], v[112:115], v[32:35]
    ds_read_b128 v[92:95], v11 offset:5120
    v_mfma_f32_16x16x32_bf16 v[36:39], v[56:59], v[112:115], v[36:39]
    ds_read_b128 v[96:99], v11 offset:6144
    v_mfma_f32_16x16x32_bf16 v[40:43], v[60:63], v[112:115], v[40:43]
    ds_read_b128 v[100:103], v11 offset:7168
    v_mfma_f32_16x16x32_bf16 v[44:47], v[64:67], v[112:115], v[44:47]
    ds_read_b128 v[104:107], v11 offset:8192
    v_mfma_f32_16x16x32_bf16 v[48:51], v[68:71], v[112:115], v[48:51]
    ds_read_b128 v[108:111], v11 offset:9216
    buffer_load_dwordx4 v[144:147], v8, s[16:19], s55 offen offset:0 sc1
    s_waitcnt vmcnt(7) lgkmcnt(5)
    v_mfma_f32_16x16x32_bf16 v[32:35], v[72:75], v[116:119], v[32:35]
    ds_read_b128 v[52:55], v10 offset:1024
    v_mfma_f32_16x16x32_bf16 v[36:39], v[76:79], v[116:119], v[36:39]
    ds_read_b128 v[56:59], v10 offset:2048
    v_mfma_f32_16x16x32_bf16 v[40:43], v[80:83], v[116:119], v[40:43]
    ds_read_b128 v[60:63], v10 offset:3072
    v_mfma_f32_16x16x32_bf16 v[44:47], v[84:87], v[116:119], v[44:47]
    ds_read_b128 v[64:67], v10 offset:4096
    v_mfma_f32_16x16x32_bf16 v[48:51], v[88:91], v[116:119], v[48:51]
    ds_read_b128 v[68:71], v10 offset:5120
    buffer_load_dwordx4 v[112:115], v8, s[16:19], s55 offen offset:2048 sc1
    s_add_u32 s55, s55, 4096
    s_waitcnt vmcnt(7) lgkmcnt(5)
    v_mfma_f32_16x16x32_bf16 v[32:35], v[92:95], v[120:123], v[32:35]
    ds_read_b128 v[72:75], v9 offset:5120
    v_mfma_f32_16x16x32_bf16 v[36:39], v[96:99], v[120:123], v[36:39]
    ds_read_b128 v[76:79], v9 offset:6144
    v_mfma_f32_16x16x32_bf16 v[40:43], v[100:103], v[120:123], v[40:43]
    ds_read_b128 v[80:83], v9 offset:7168
    v_mfma_f32_16x16x32_bf16 v[44:47], v[104:107], v[120:123], v[44:47]
    ds_read_b128 v[84:87], v9 offset:8192
    v_mfma_f32_16x16x32_bf16 v[48:51], v[108:111], v[120:123], v[48:51]
    ds_read_b128 v[88:91], v9 offset:9216
    buffer_load_dwordx4 v[116:119], v8, s[16:19], s55 offen offset:0 sc1
    s_waitcnt vmcnt(7) lgkmcnt(5)
    s_barrier
    v_mfma_f32_16x16x32_bf16 v[32:35], v[52:55], v[124:127], v[32:35]
    ds_read_b128 v[92:95], v9 offset:15360
    v_mfma_f32_16x16x32_bf16 v[36:39], v[56:59], v[124:127], v[36:39]
    ds_read_b128 v[96:99], v9 offset:16384
    v_mfma_f32_16x16x32_bf16 v[40:43], v[60:63], v[124:127], v[40:43]
    ds_read_b128 v[100:103], v9 offset:17408
    v_mfma_f32_16x16x32_bf16 v[44:47], v[64:67], v[124:127], v[44:47]
    ds_read_b128 v[104:107], v9 offset:18432
    v_mfma_f32_16x16x32_bf16 v[48:51], v[68:71], v[124:127], v[48:51]
    ds_read_b128 v[108:111], v9 offset:19456
    buffer_load_dwordx4 v[120:123], v8, s[16:19], s55 offen offset:2048 sc1
    s_add_u32 s55, s55, 4096
    s_waitcnt vmcnt(7) lgkmcnt(5)
    v_mfma_f32_16x16x32_bf16 v[32:35], v[72:75], v[128:131], v[32:35]
    ds_read_b128 v[52:55], v9 offset:25600
    v_mfma_f32_16x16x32_bf16 v[36:39], v[76:79], v[128:131], v[36:39]
    ds_read_b128 v[56:59], v9 offset:26624
    v_mfma_f32_16x16x32_bf16 v[40:43], v[80:83], v[128:131], v[40:43]
    ds_read_b128 v[60:63], v9 offset:27648
    v_mfma_f32_16x16x32_bf16 v[44:47], v[84:87], v[128:131], v[44:47]
    ds_read_b128 v[64:67], v9 offset:28672
    v_mfma_f32_16x16x32_bf16 v[48:51], v[88:91], v[128:131], v[48:51]
    ds_read_b128 v[68:71], v9 offset:29696
    buffer_load_dwordx4 v[124:127], v8, s[16:19], s55 offen offset:0 sc1
    s_waitcnt vmcnt(7) lgkmcnt(5)
    v_mfma_f32_16x16x32_bf16 v[32:35], v[92:95], v[132:135], v[32:35]
    ds_read_b128 v[72:75], v11 offset:17408
    v_mfma_f32_16x16x32_bf16 v[36:39], v[96:99], v[132:135], v[36:39]
    ds_read_b128 v[76:79], v11 offset:18432
    v_mfma_f32_16x16x32_bf16 v[40:43], v[100:103], v[132:135], v[40:43]
    ds_read_b128 v[80:83], v11 offset:19456
    v_mfma_f32_16x16x32_bf16 v[44:47], v[104:107], v[132:135], v[44:47]
    ds_read_b128 v[84:87], v11 offset:20480
    v_mfma_f32_16x16x32_bf16 v[48:51], v[108:111], v[132:135], v[48:51]
    ds_read_b128 v[88:91], v11 offset:21504
    buffer_load_dwordx4 v[128:131], v8, s[16:19], s55 offen offset:2048 sc1
    s_add_u32 s55, s55, 4096
    s_waitcnt vmcnt(7) lgkmcnt(5)
    v_mfma_f32_16x16x32_bf16 v[32:35], v[52:55], v[136:139], v[32:35]
    ds_read_b128 v[92:95], v10 offset:6144
    v_mfma_f32_16x16x32_bf16 v[36:39], v[56:59], v[136:139], v[36:39]
    ds_read_b128 v[96:99], v10 offset:7168
    v_mfma_f32_16x16x32_bf16 v[40:43], v[60:63], v[136:139], v[40:43]
    ds_read_b128 v[100:103], v10 offset:8192
    v_mfma_f32_16x16x32_bf16 v[44:47], v[64:67], v[136:139], v[44:47]
    ds_read_b128 v[104:107], v10 offset:9216
    v_mfma_f32_16x16x32_bf16 v[48:51], v[68:71], v[136:139], v[48:51]
    ds_read_b128 v[108:111], v10 offset:10240
    buffer_load_dwordx4 v[132:135], v8, s[16:19], s55 offen offset:0 sc1
    s_waitcnt vmcnt(7) lgkmcnt(5)
    v_mfma_f32_16x16x32_bf16 v[32:35], v[72:75], v[140:143], v[32:35]
    ds_read_b128 v[52:55], v9 offset:30720
    v_mfma_f32_16x16x32_bf16 v[36:39], v[76:79], v[140:143], v[36:39]
    ds_read_b128 v[56:59], v9 offset:31744
    v_mfma_f32_16x16x32_bf16 v[40:43], v[80:83], v[140:143], v[40:43]
    ds_read_b128 v[60:63], v9 offset:32768
    v_mfma_f32_16x16x32_bf16 v[44:47], v[84:87], v[140:143], v[44:47]
    ds_read_b128 v[64:67], v9 offset:33792
    v_mfma_f32_16x16x32_bf16 v[48:51], v[88:91], v[140:143], v[48:51]
    ds_read_b128 v[68:71], v9 offset:34816
    buffer_load_dwordx4 v[136:139], v8, s[16:19], s55 offen offset:2048 sc1
    s_add_u32 s55, s55, 4096
    s_waitcnt vmcnt(7) lgkmcnt(5)
    s_barrier
    v_mfma_f32_16x16x32_bf16 v[32:35], v[92:95], v[144:147], v[32:35]
    ds_read_b128 v[72:75], v9 offset:40960
    v_mfma_f32_16x16x32_bf16 v[36:39], v[96:99], v[144:147], v[36:39]
    ds_read_b128 v[76:79], v9 offset:41984
    v_mfma_f32_16x16x32_bf16 v[40:43], v[100:103], v[144:147], v[40:43]
    ds_read_b128 v[80:83], v9 offset:43008
    v_mfma_f32_16x16x32_bf16 v[44:47], v[104:107], v[144:147], v[44:47]
    ds_read_b128 v[84:87], v9 offset:44032
    v_mfma_f32_16x16x32_bf16 v[48:51], v[108:111], v[144:147], v[48:51]
    ds_read_b128 v[88:91], v9 offset:45056
    buffer_load_dwordx4 v[140:143], v8, s[16:19], s55 offen offset:0 sc1
    s_waitcnt vmcnt(7) lgkmcnt(5)
    v_mfma_f32_16x16x32_bf16 v[32:35], v[52:55], v[112:115], v[32:35]
    ds_read_b128 v[92:95], v9 offset:51200
    v_mfma_f32_16x16x32_bf16 v[36:39], v[56:59], v[112:115], v[36:39]
    ds_read_b128 v[96:99], v9 offset:52224
    v_mfma_f32_16x16x32_bf16 v[40:43], v[60:63], v[112:115], v[40:43]
    ds_read_b128 v[100:103], v9 offset:53248
    v_mfma_f32_16x16x32_bf16 v[44:47], v[64:67], v[112:115], v[44:47]
    ds_read_b128 v[104:107], v9 offset:54272
    v_mfma_f32_16x16x32_bf16 v[48:51], v[68:71], v[112:115], v[48:51]
    ds_read_b128 v[108:111], v9 offset:55296
    buffer_load_dwordx4 v[144:147], v8, s[16:19], s55 offen offset:2048 sc1
    s_add_u32 s55, s55, 4096
    s_waitcnt vmcnt(7) lgkmcnt(5)
    v_mfma_f32_16x16x32_bf16 v[32:35], v[72:75], v[116:119], v[32:35]
    ds_read_b128 v[52:55], v10 offset:16384
    v_mfma_f32_16x16x32_bf16 v[36:39], v[76:79], v[116:119], v[36:39]
    ds_read_b128 v[56:59], v10 offset:17408
    v_mfma_f32_16x16x32_bf16 v[40:43], v[80:83], v[116:119], v[40:43]
    ds_read_b128 v[60:63], v10 offset:18432
    v_mfma_f32_16x16x32_bf16 v[44:47], v[84:87], v[116:119], v[44:47]
    ds_read_b128 v[64:67], v10 offset:19456
    v_mfma_f32_16x16x32_bf16 v[48:51], v[88:91], v[116:119], v[48:51]
    ds_read_b128 v[68:71], v10 offset:20480
    buffer_load_dwordx4 v[112:115], v8, s[16:19], s55 offen offset:0 sc1
    s_waitcnt vmcnt(7) lgkmcnt(5)
    v_mfma_f32_16x16x32_bf16 v[32:35], v[92:95], v[120:123], v[32:35]
    ds_read_b128 v[72:75], v10 offset:26624
    v_mfma_f32_16x16x32_bf16 v[36:39], v[96:99], v[120:123], v[36:39]
    ds_read_b128 v[76:79], v10 offset:27648
    v_mfma_f32_16x16x32_bf16 v[40:43], v[100:103], v[120:123], v[40:43]
    ds_read_b128 v[80:83], v10 offset:28672
    v_mfma_f32_16x16x32_bf16 v[44:47], v[104:107], v[120:123], v[44:47]
    ds_read_b128 v[84:87], v10 offset:29696
    v_mfma_f32_16x16x32_bf16 v[48:51], v[108:111], v[120:123], v[48:51]
    ds_read_b128 v[88:91], v10 offset:30720
    buffer_load_dwordx4 v[116:119], v8, s[16:19], s55 offen offset:2048 sc1
    s_add_u32 s55, s55, 4096
    s_waitcnt vmcnt(7) lgkmcnt(5)
    v_mfma_f32_16x16x32_bf16 v[32:35], v[52:55], v[124:127], v[32:35]
    ds_read_b128 v[92:95], v10 offset:36864
    v_mfma_f32_16x16x32_bf16 v[36:39], v[56:59], v[124:127], v[36:39]
    ds_read_b128 v[96:99], v10 offset:37888
    v_mfma_f32_16x16x32_bf16 v[40:43], v[60:63], v[124:127], v[40:43]
    ds_read_b128 v[100:103], v10 offset:38912
    v_mfma_f32_16x16x32_bf16 v[44:47], v[64:67], v[124:127], v[44:47]
    ds_read_b128 v[104:107], v10 offset:39936
    v_mfma_f32_16x16x32_bf16 v[48:51], v[68:71], v[124:127], v[48:51]
    ds_read_b128 v[108:111], v10 offset:40960
    buffer_load_dwordx4 v[120:123], v8, s[16:19], s55 offen offset:0 sc1
    s_waitcnt vmcnt(7) lgkmcnt(5)
    s_barrier
    v_mfma_f32_16x16x32_bf16 v[32:35], v[72:75], v[128:131], v[32:35]
    ds_read_b128 v[52:55], v10 offset:50176
    v_mfma_f32_16x16x32_bf16 v[36:39], v[76:79], v[128:131], v[36:39]
    ds_read_b128 v[56:59], v10 offset:51200
    v_mfma_f32_16x16x32_bf16 v[40:43], v[80:83], v[128:131], v[40:43]
    ds_read_b128 v[60:63], v10 offset:52224
    v_mfma_f32_16x16x32_bf16 v[44:47], v[84:87], v[128:131], v[44:47]
    ds_read_b128 v[64:67], v10 offset:53248
    v_mfma_f32_16x16x32_bf16 v[48:51], v[88:91], v[128:131], v[48:51]
    ds_read_b128 v[68:71], v10 offset:54272
    buffer_load_dwordx4 v[124:127], v8, s[16:19], s55 offen offset:2048 sc1
    s_add_u32 s55, s55, 4096
    s_waitcnt vmcnt(7) lgkmcnt(5)
    v_mfma_f32_16x16x32_bf16 v[32:35], v[92:95], v[132:135], v[32:35]
    ds_read_b128 v[72:75], v10 offset:60416
    v_mfma_f32_16x16x32_bf16 v[36:39], v[96:99], v[132:135], v[36:39]
    ds_read_b128 v[76:79], v10 offset:61440
    v_mfma_f32_16x16x32_bf16 v[40:43], v[100:103], v[132:135], v[40:43]
    ds_read_b128 v[80:83], v10 offset:62464
    v_mfma_f32_16x16x32_bf16 v[44:47], v[104:107], v[132:135], v[44:47]
    ds_read_b128 v[84:87], v10 offset:63488
    v_mfma_f32_16x16x32_bf16 v[48:51], v[108:111], v[132:135], v[48:51]
    ds_read_b128 v[88:91], v10 offset:64512
    buffer_load_dwordx4 v[128:131], v8, s[16:19], s55 offen offset:0 sc1
    s_waitcnt vmcnt(7) lgkmcnt(5)
    v_mfma_f32_16x16x32_bf16 v[32:35], v[52:55], v[136:139], v[32:35]
    ds_read_b128 v[92:95], v11 offset:5120
    v_mfma_f32_16x16x32_bf16 v[36:39], v[56:59], v[136:139], v[36:39]
    ds_read_b128 v[96:99], v11 offset:6144
    v_mfma_f32_16x16x32_bf16 v[40:43], v[60:63], v[136:139], v[40:43]
    ds_read_b128 v[100:103], v11 offset:7168
    v_mfma_f32_16x16x32_bf16 v[44:47], v[64:67], v[136:139], v[44:47]
    ds_read_b128 v[104:107], v11 offset:8192
    v_mfma_f32_16x16x32_bf16 v[48:51], v[68:71], v[136:139], v[48:51]
    ds_read_b128 v[108:111], v11 offset:9216
    buffer_load_dwordx4 v[132:135], v8, s[16:19], s55 offen offset:2048 sc1
    s_add_u32 s55, s55, 4096
    s_waitcnt vmcnt(7) lgkmcnt(5)
    s_barrier
    v_mfma_f32_16x16x32_bf16 v[32:35], v[72:75], v[140:143], v[32:35]
    ds_read_b128 v[52:55], v10 offset:1024
    v_mfma_f32_16x16x32_bf16 v[36:39], v[76:79], v[140:143], v[36:39]
    ds_read_b128 v[56:59], v10 offset:2048
    v_mfma_f32_16x16x32_bf16 v[40:43], v[80:83], v[140:143], v[40:43]
    ds_read_b128 v[60:63], v10 offset:3072
    v_mfma_f32_16x16x32_bf16 v[44:47], v[84:87], v[140:143], v[44:47]
    ds_read_b128 v[64:67], v10 offset:4096
    v_mfma_f32_16x16x32_bf16 v[48:51], v[88:91], v[140:143], v[48:51]
    ds_read_b128 v[68:71], v10 offset:5120
    s_waitcnt vmcnt(6) lgkmcnt(5)
    v_mfma_f32_16x16x32_bf16 v[32:35], v[92:95], v[144:147], v[32:35]
    ds_read_b128 v[72:75], v9 offset:5120
    v_mfma_f32_16x16x32_bf16 v[36:39], v[96:99], v[144:147], v[36:39]
    ds_read_b128 v[76:79], v9 offset:6144
    v_mfma_f32_16x16x32_bf16 v[40:43], v[100:103], v[144:147], v[40:43]
    ds_read_b128 v[80:83], v9 offset:7168
    v_mfma_f32_16x16x32_bf16 v[44:47], v[104:107], v[144:147], v[44:47]
    ds_read_b128 v[84:87], v9 offset:8192
    v_mfma_f32_16x16x32_bf16 v[48:51], v[108:111], v[144:147], v[48:51]
    ds_read_b128 v[88:91], v9 offset:9216
    s_waitcnt vmcnt(5) lgkmcnt(5)
    v_mfma_f32_16x16x32_bf16 v[32:35], v[52:55], v[112:115], v[32:35]
    ds_read_b128 v[92:95], v9 offset:15360
    v_mfma_f32_16x16x32_bf16 v[36:39], v[56:59], v[112:115], v[36:39]
    ds_read_b128 v[96:99], v9 offset:16384
    v_mfma_f32_16x16x32_bf16 v[40:43], v[60:63], v[112:115], v[40:43]
    ds_read_b128 v[100:103], v9 offset:17408
    v_mfma_f32_16x16x32_bf16 v[44:47], v[64:67], v[112:115], v[44:47]
    ds_read_b128 v[104:107], v9 offset:18432
    v_mfma_f32_16x16x32_bf16 v[48:51], v[68:71], v[112:115], v[48:51]
    ds_read_b128 v[108:111], v9 offset:19456
    s_waitcnt vmcnt(4) lgkmcnt(5)
    s_barrier
    v_mfma_f32_16x16x32_bf16 v[32:35], v[72:75], v[116:119], v[32:35]
    ds_read_b128 v[52:55], v9 offset:25600
    v_mfma_f32_16x16x32_bf16 v[36:39], v[76:79], v[116:119], v[36:39]
    ds_read_b128 v[56:59], v9 offset:26624
    v_mfma_f32_16x16x32_bf16 v[40:43], v[80:83], v[116:119], v[40:43]
    ds_read_b128 v[60:63], v9 offset:27648
    v_mfma_f32_16x16x32_bf16 v[44:47], v[84:87], v[116:119], v[44:47]
    ds_read_b128 v[64:67], v9 offset:28672
    v_mfma_f32_16x16x32_bf16 v[48:51], v[88:91], v[116:119], v[48:51]
    ds_read_b128 v[68:71], v9 offset:29696
    s_waitcnt vmcnt(3) lgkmcnt(5)
    v_mfma_f32_16x16x32_bf16 v[32:35], v[92:95], v[120:123], v[32:35]
    ds_read_b128 v[72:75], v11 offset:17408
    v_mfma_f32_16x16x32_bf16 v[36:39], v[96:99], v[120:123], v[36:39]
    ds_read_b128 v[76:79], v11 offset:18432
    v_mfma_f32_16x16x32_bf16 v[40:43], v[100:103], v[120:123], v[40:43]
    ds_read_b128 v[80:83], v11 offset:19456
    v_mfma_f32_16x16x32_bf16 v[44:47], v[104:107], v[120:123], v[44:47]
    ds_read_b128 v[84:87], v11 offset:20480
    v_mfma_f32_16x16x32_bf16 v[48:51], v[108:111], v[120:123], v[48:51]
    ds_read_b128 v[88:91], v11 offset:21504
    s_waitcnt vmcnt(2) lgkmcnt(5)
    v_mfma_f32_16x16x32_bf16 v[32:35], v[52:55], v[124:127], v[32:35]
    ds_read_b128 v[92:95], v10 offset:6144
    v_mfma_f32_16x16x32_bf16 v[36:39], v[56:59], v[124:127], v[36:39]
    ds_read_b128 v[96:99], v10 offset:7168
    v_mfma_f32_16x16x32_bf16 v[40:43], v[60:63], v[124:127], v[40:43]
    ds_read_b128 v[100:103], v10 offset:8192
    v_mfma_f32_16x16x32_bf16 v[44:47], v[64:67], v[124:127], v[44:47]
    ds_read_b128 v[104:107], v10 offset:9216
    v_mfma_f32_16x16x32_bf16 v[48:51], v[68:71], v[124:127], v[48:51]
    ds_read_b128 v[108:111], v10 offset:10240
    s_waitcnt vmcnt(1) lgkmcnt(5)
    v_mfma_f32_16x16x32_bf16 v[32:35], v[72:75], v[128:131], v[32:35]
    v_mfma_f32_16x16x32_bf16 v[36:39], v[76:79], v[128:131], v[36:39]
    v_mfma_f32_16x16x32_bf16 v[40:43], v[80:83], v[128:131], v[40:43]
    v_mfma_f32_16x16x32_bf16 v[44:47], v[84:87], v[128:131], v[44:47]
    v_mfma_f32_16x16x32_bf16 v[48:51], v[88:91], v[128:131], v[48:51]
    s_waitcnt vmcnt(0) lgkmcnt(0)
    v_mfma_f32_16x16x32_bf16 v[32:35], v[92:95], v[132:135], v[32:35]
    v_mfma_f32_16x16x32_bf16 v[36:39], v[96:99], v[132:135], v[36:39]
    v_mfma_f32_16x16x32_bf16 v[40:43], v[100:103], v[132:135], v[40:43]
    v_mfma_f32_16x16x32_bf16 v[44:47], v[104:107], v[132:135], v[44:47]
    v_mfma_f32_16x16x32_bf16 v[48:51], v[108:111], v[132:135], v[48:51]
    s_mul_i32 s31, s24, 5120
    s_add_u32 s31, s31, 30720
    v_add_u32 v2, s31, v8
    s_mov_b32 s33, 0xffff0000
    v_lshlrev_b32 v52, 16, v16
    v_and_b32 v53, s33, v16
    v_lshlrev_b32 v54, 16, v17
    v_and_b32 v55, s33, v17
    v_lshlrev_b32 v56, 16, v18
    v_and_b32 v57, s33, v18
    v_lshlrev_b32 v58, 16, v19
    v_and_b32 v59, s33, v19
    v_lshlrev_b32 v60, 16, v20
    v_and_b32 v61, s33, v20
    v_lshlrev_b32 v62, 16, v21
    v_and_b32 v63, s33, v21
    v_lshlrev_b32 v64, 16, v22
    v_and_b32 v65, s33, v22
    v_lshlrev_b32 v66, 16, v23
    v_and_b32 v67, s33, v23
    v_lshlrev_b32 v68, 16, v24
    v_and_b32 v69, s33, v24
    v_lshlrev_b32 v70, 16, v25
    v_and_b32 v71, s33, v25
    v_pk_add_f32 v[32:33], v[32:33], v[52:53]
    v_pk_add_f32 v[34:35], v[34:35], v[54:55]
    v_pk_add_f32 v[36:37], v[36:37], v[56:57]
    v_pk_add_f32 v[38:39], v[38:39], v[58:59]
    v_pk_add_f32 v[40:41], v[40:41], v[60:61]
    v_pk_add_f32 v[42:43], v[42:43], v[62:63]
    v_pk_add_f32 v[44:45], v[44:45], v[64:65]
    v_pk_add_f32 v[46:47], v[46:47], v[66:67]
    v_pk_add_f32 v[48:49], v[48:49], v[68:69]
    v_pk_add_f32 v[50:51], v[50:51], v[70:71]
    s_barrier
    ds_read_b128 v[52:55], v2 offset:0
    ds_read_b128 v[56:59], v2 offset:1024
    ds_read_b128 v[60:63], v2 offset:2048
    ds_read_b128 v[64:67], v2 offset:3072
    ds_read_b128 v[68:71], v2 offset:4096
    s_waitcnt lgkmcnt(4)
    v_pk_add_f32 v[32:33], v[32:33], v[52:53]
    v_cvt_pk_bf16_f32 v16, v32, v33
    v_pk_add_f32 v[34:35], v[34:35], v[54:55]
    v_cvt_pk_bf16_f32 v17, v34, v35
    s_waitcnt lgkmcnt(3)
    v_pk_add_f32 v[36:37], v[36:37], v[56:57]
    v_cvt_pk_bf16_f32 v18, v36, v37
    v_pk_add_f32 v[38:39], v[38:39], v[58:59]
    v_cvt_pk_bf16_f32 v19, v38, v39
    buffer_store_dwordx4 v[16:19], v12, s[8:11], 0 offen
    s_waitcnt lgkmcnt(2)
    v_pk_add_f32 v[40:41], v[40:41], v[60:61]
    v_cvt_pk_bf16_f32 v20, v40, v41
    v_pk_add_f32 v[42:43], v[42:43], v[62:63]
    v_cvt_pk_bf16_f32 v21, v42, v43
    s_waitcnt lgkmcnt(1)
    v_pk_add_f32 v[44:45], v[44:45], v[64:65]
    v_cvt_pk_bf16_f32 v22, v44, v45
    v_pk_add_f32 v[46:47], v[46:47], v[66:67]
    v_cvt_pk_bf16_f32 v23, v46, v47
    buffer_store_dwordx4 v[20:23], v12, s[8:11], 0 offen offset:16
    s_waitcnt lgkmcnt(0)
    v_pk_add_f32 v[48:49], v[48:49], v[68:69]
    v_cvt_pk_bf16_f32 v24, v48, v49
    v_pk_add_f32 v[50:51], v[50:51], v[70:71]
    v_cvt_pk_bf16_f32 v25, v50, v51
    buffer_store_dwordx2 v[24:25], v12, s[8:11], 0 offen offset:32
    s_branch L_kf_fin
L_kf_p5odd:
    s_mul_i32 s55, s56, 49152
    s_add_u32 s55, s55, 13632512
    v_mov_b32 v32, 0
    v_mov_b32 v33, 0
    v_mov_b32 v34, 0
    v_mov_b32 v35, 0
    v_mov_b32 v36, 0
    v_mov_b32 v37, 0
    v_mov_b32 v38, 0
    v_mov_b32 v39, 0
    v_mov_b32 v40, 0
    v_mov_b32 v41, 0
    v_mov_b32 v42, 0
    v_mov_b32 v43, 0
    v_mov_b32 v44, 0
    v_mov_b32 v45, 0
    v_mov_b32 v46, 0
    v_mov_b32 v47, 0
    v_mov_b32 v48, 0
    v_mov_b32 v49, 0
    v_mov_b32 v50, 0
    v_mov_b32 v51, 0
    v_lshlrev_b32 v8, 4, v1
    v_mov_b32 v9, v8
    v_add_u32 v10, 65536, v8
    v_add_u32 v11, 131072, v8
    s_barrier
    buffer_load_dwordx4 v[112:115], v8, s[16:19], s55 offen offset:0 sc1
    buffer_load_dwordx4 v[116:119], v8, s[16:19], s55 offen offset:2048 sc1
    s_add_u32 s55, s55, 4096
    buffer_load_dwordx4 v[120:123], v8, s[16:19], s55 offen offset:0 sc1
    buffer_load_dwordx4 v[124:127], v8, s[16:19], s55 offen offset:2048 sc1
    s_add_u32 s55, s55, 4096
    buffer_load_dwordx4 v[128:131], v8, s[16:19], s55 offen offset:0 sc1
    buffer_load_dwordx4 v[132:135], v8, s[16:19], s55 offen offset:2048 sc1
    s_add_u32 s55, s55, 4096
    buffer_load_dwordx4 v[136:139], v8, s[16:19], s55 offen offset:0 sc1
    buffer_load_dwordx4 v[140:143], v8, s[16:19], s55 offen offset:2048 sc1
    s_add_u32 s55, s55, 4096
    ds_read_b128 v[52:55], v10 offset:55296
    ds_read_b128 v[56:59], v10 offset:56320
    ds_read_b128 v[60:63], v10 offset:57344
    ds_read_b128 v[64:67], v10 offset:58368
    ds_read_b128 v[68:71], v10 offset:59392
    ds_read_b128 v[72:75], v11 offset:0
    ds_read_b128 v[76:79], v11 offset:1024
    ds_read_b128 v[80:83], v11 offset:2048
    ds_read_b128 v[84:87], v11 offset:3072
    ds_read_b128 v[88:91], v11 offset:4096
    s_waitcnt vmcnt(7) lgkmcnt(5)
    v_mfma_f32_16x16x32_bf16 v[32:35], v[52:55], v[112:115], v[32:35]
    ds_read_b128 v[92:95], v9 offset:61440
    v_mfma_f32_16x16x32_bf16 v[36:39], v[56:59], v[112:115], v[36:39]
    ds_read_b128 v[96:99], v9 offset:62464
    v_mfma_f32_16x16x32_bf16 v[40:43], v[60:63], v[112:115], v[40:43]
    ds_read_b128 v[100:103], v9 offset:63488
    v_mfma_f32_16x16x32_bf16 v[44:47], v[64:67], v[112:115], v[44:47]
    ds_read_b128 v[104:107], v9 offset:64512
    v_mfma_f32_16x16x32_bf16 v[48:51], v[68:71], v[112:115], v[48:51]
    ds_read_b128 v[108:111], v10 offset:0
    buffer_load_dwordx4 v[144:147], v8, s[16:19], s55 offen offset:0 sc1
    s_waitcnt vmcnt(7) lgkmcnt(5)
    v_mfma_f32_16x16x32_bf16 v[32:35], v[72:75], v[116:119], v[32:35]
    ds_read_b128 v[52:55], v9 offset:0
    v_mfma_f32_16x16x32_bf16 v[36:39], v[76:79], v[116:119], v[36:39]
    ds_read_b128 v[56:59], v9 offset:1024
    v_mfma_f32_16x16x32_bf16 v[40:43], v[80:83], v[116:119], v[40:43]
    ds_read_b128 v[60:63], v9 offset:2048
    v_mfma_f32_16x16x32_bf16 v[44:47], v[84:87], v[116:119], v[44:47]
    ds_read_b128 v[64:67], v9 offset:3072
    v_mfma_f32_16x16x32_bf16 v[48:51], v[88:91], v[116:119], v[48:51]
    ds_read_b128 v[68:71], v9 offset:4096
    buffer_load_dwordx4 v[112:115], v8, s[16:19], s55 offen offset:2048 sc1
    s_add_u32 s55, s55, 4096
    s_waitcnt vmcnt(7) lgkmcnt(5)
    v_mfma_f32_16x16x32_bf16 v[32:35], v[92:95], v[120:123], v[32:35]
    ds_read_b128 v[72:75], v9 offset:10240
    v_mfma_f32_16x16x32_bf16 v[36:39], v[96:99], v[120:123], v[36:39]
    ds_read_b128 v[76:79], v9 offset:11264
    v_mfma_f32_16x16x32_bf16 v[40:43], v[100:103], v[120:123], v[40:43]
    ds_read_b128 v[80:83], v9 offset:12288
    v_mfma_f32_16x16x32_bf16 v[44:47], v[104:107], v[120:123], v[44:47]
    ds_read_b128 v[84:87], v9 offset:13312
    v_mfma_f32_16x16x32_bf16 v[48:51], v[108:111], v[120:123], v[48:51]
    ds_read_b128 v[88:91], v9 offset:14336
    buffer_load_dwordx4 v[116:119], v8, s[16:19], s55 offen offset:0 sc1
    s_waitcnt vmcnt(7) lgkmcnt(5)
    s_barrier
    v_mfma_f32_16x16x32_bf16 v[32:35], v[52:55], v[124:127], v[32:35]
    ds_read_b128 v[92:95], v9 offset:20480
    v_mfma_f32_16x16x32_bf16 v[36:39], v[56:59], v[124:127], v[36:39]
    ds_read_b128 v[96:99], v9 offset:21504
    v_mfma_f32_16x16x32_bf16 v[40:43], v[60:63], v[124:127], v[40:43]
    ds_read_b128 v[100:103], v9 offset:22528
    v_mfma_f32_16x16x32_bf16 v[44:47], v[64:67], v[124:127], v[44:47]
    ds_read_b128 v[104:107], v9 offset:23552
    v_mfma_f32_16x16x32_bf16 v[48:51], v[68:71], v[124:127], v[48:51]
    ds_read_b128 v[108:111], v9 offset:24576
    buffer_load_dwordx4 v[120:123], v8, s[16:19], s55 offen offset:2048 sc1
    s_add_u32 s55, s55, 4096
    s_waitcnt vmcnt(7) lgkmcnt(5)
    v_mfma_f32_16x16x32_bf16 v[32:35], v[72:75], v[128:131], v[32:35]
    ds_read_b128 v[52:55], v11 offset:12288
    v_mfma_f32_16x16x32_bf16 v[36:39], v[76:79], v[128:131], v[36:39]
    ds_read_b128 v[56:59], v11 offset:13312
    v_mfma_f32_16x16x32_bf16 v[40:43], v[80:83], v[128:131], v[40:43]
    ds_read_b128 v[60:63], v11 offset:14336
    v_mfma_f32_16x16x32_bf16 v[44:47], v[84:87], v[128:131], v[44:47]
    ds_read_b128 v[64:67], v11 offset:15360
    v_mfma_f32_16x16x32_bf16 v[48:51], v[88:91], v[128:131], v[48:51]
    ds_read_b128 v[68:71], v11 offset:16384
    buffer_load_dwordx4 v[124:127], v8, s[16:19], s55 offen offset:0 sc1
    s_waitcnt vmcnt(7) lgkmcnt(5)
    v_mfma_f32_16x16x32_bf16 v[32:35], v[92:95], v[132:135], v[32:35]
    ds_read_b128 v[72:75], v11 offset:22528
    v_mfma_f32_16x16x32_bf16 v[36:39], v[96:99], v[132:135], v[36:39]
    ds_read_b128 v[76:79], v11 offset:23552
    v_mfma_f32_16x16x32_bf16 v[40:43], v[100:103], v[132:135], v[40:43]
    ds_read_b128 v[80:83], v11 offset:24576
    v_mfma_f32_16x16x32_bf16 v[44:47], v[104:107], v[132:135], v[44:47]
    ds_read_b128 v[84:87], v11 offset:25600
    v_mfma_f32_16x16x32_bf16 v[48:51], v[108:111], v[132:135], v[48:51]
    ds_read_b128 v[88:91], v11 offset:26624
    buffer_load_dwordx4 v[128:131], v8, s[16:19], s55 offen offset:2048 sc1
    s_add_u32 s55, s55, 4096
    s_waitcnt vmcnt(7) lgkmcnt(5)
    v_mfma_f32_16x16x32_bf16 v[32:35], v[52:55], v[136:139], v[32:35]
    ds_read_b128 v[92:95], v10 offset:11264
    v_mfma_f32_16x16x32_bf16 v[36:39], v[56:59], v[136:139], v[36:39]
    ds_read_b128 v[96:99], v10 offset:12288
    v_mfma_f32_16x16x32_bf16 v[40:43], v[60:63], v[136:139], v[40:43]
    ds_read_b128 v[100:103], v10 offset:13312
    v_mfma_f32_16x16x32_bf16 v[44:47], v[64:67], v[136:139], v[44:47]
    ds_read_b128 v[104:107], v10 offset:14336
    v_mfma_f32_16x16x32_bf16 v[48:51], v[68:71], v[136:139], v[48:51]
    ds_read_b128 v[108:111], v10 offset:15360
    buffer_load_dwordx4 v[132:135], v8, s[16:19], s55 offen offset:0 sc1
    s_waitcnt vmcnt(7) lgkmcnt(5)
    v_mfma_f32_16x16x32_bf16 v[32:35], v[72:75], v[140:143], v[32:35]
    ds_read_b128 v[52:55], v9 offset:35840
    v_mfma_f32_16x16x32_bf16 v[36:39], v[76:79], v[140:143], v[36:39]
    ds_read_b128 v[56:59], v9 offset:36864
    v_mfma_f32_16x16x32_bf16 v[40:43], v[80:83], v[140:143], v[40:43]
    ds_read_b128 v[60:63], v9 offset:37888
    v_mfma_f32_16x16x32_bf16 v[44:47], v[84:87], v[140:143], v[44:47]
    ds_read_b128 v[64:67], v9 offset:38912
    v_mfma_f32_16x16x32_bf16 v[48:51], v[88:91], v[140:143], v[48:51]
    ds_read_b128 v[68:71], v9 offset:39936
    buffer_load_dwordx4 v[136:139], v8, s[16:19], s55 offen offset:2048 sc1
    s_add_u32 s55, s55, 4096
    s_waitcnt vmcnt(7) lgkmcnt(5)
    s_barrier
    v_mfma_f32_16x16x32_bf16 v[32:35], v[92:95], v[144:147], v[32:35]
    ds_read_b128 v[72:75], v9 offset:46080
    v_mfma_f32_16x16x32_bf16 v[36:39], v[96:99], v[144:147], v[36:39]
    ds_read_b128 v[76:79], v9 offset:47104
    v_mfma_f32_16x16x32_bf16 v[40:43], v[100:103], v[144:147], v[40:43]
    ds_read_b128 v[80:83], v9 offset:48128
    v_mfma_f32_16x16x32_bf16 v[44:47], v[104:107], v[144:147], v[44:47]
    ds_read_b128 v[84:87], v9 offset:49152
    v_mfma_f32_16x16x32_bf16 v[48:51], v[108:111], v[144:147], v[48:51]
    ds_read_b128 v[88:91], v9 offset:50176
    buffer_load_dwordx4 v[140:143], v8, s[16:19], s55 offen offset:0 sc1
    s_waitcnt vmcnt(7) lgkmcnt(5)
    v_mfma_f32_16x16x32_bf16 v[32:35], v[52:55], v[112:115], v[32:35]
    ds_read_b128 v[92:95], v9 offset:56320
    v_mfma_f32_16x16x32_bf16 v[36:39], v[56:59], v[112:115], v[36:39]
    ds_read_b128 v[96:99], v9 offset:57344
    v_mfma_f32_16x16x32_bf16 v[40:43], v[60:63], v[112:115], v[40:43]
    ds_read_b128 v[100:103], v9 offset:58368
    v_mfma_f32_16x16x32_bf16 v[44:47], v[64:67], v[112:115], v[44:47]
    ds_read_b128 v[104:107], v9 offset:59392
    v_mfma_f32_16x16x32_bf16 v[48:51], v[68:71], v[112:115], v[48:51]
    ds_read_b128 v[108:111], v9 offset:60416
    buffer_load_dwordx4 v[144:147], v8, s[16:19], s55 offen offset:2048 sc1
    s_add_u32 s55, s55, 4096
    s_waitcnt vmcnt(7) lgkmcnt(5)
    v_mfma_f32_16x16x32_bf16 v[32:35], v[72:75], v[116:119], v[32:35]
    ds_read_b128 v[52:55], v10 offset:21504
    v_mfma_f32_16x16x32_bf16 v[36:39], v[76:79], v[116:119], v[36:39]
    ds_read_b128 v[56:59], v10 offset:22528
    v_mfma_f32_16x16x32_bf16 v[40:43], v[80:83], v[116:119], v[40:43]
    ds_read_b128 v[60:63], v10 offset:23552
    v_mfma_f32_16x16x32_bf16 v[44:47], v[84:87], v[116:119], v[44:47]
    ds_read_b128 v[64:67], v10 offset:24576
    v_mfma_f32_16x16x32_bf16 v[48:51], v[88:91], v[116:119], v[48:51]
    ds_read_b128 v[68:71], v10 offset:25600
    buffer_load_dwordx4 v[112:115], v8, s[16:19], s55 offen offset:0 sc1
    s_waitcnt vmcnt(7) lgkmcnt(5)
    v_mfma_f32_16x16x32_bf16 v[32:35], v[92:95], v[120:123], v[32:35]
    ds_read_b128 v[72:75], v10 offset:31744
    v_mfma_f32_16x16x32_bf16 v[36:39], v[96:99], v[120:123], v[36:39]
    ds_read_b128 v[76:79], v10 offset:32768
    v_mfma_f32_16x16x32_bf16 v[40:43], v[100:103], v[120:123], v[40:43]
    ds_read_b128 v[80:83], v10 offset:33792
    v_mfma_f32_16x16x32_bf16 v[44:47], v[104:107], v[120:123], v[44:47]
    ds_read_b128 v[84:87], v10 offset:34816
    v_mfma_f32_16x16x32_bf16 v[48:51], v[108:111], v[120:123], v[48:51]
    ds_read_b128 v[88:91], v10 offset:35840
    buffer_load_dwordx4 v[116:119], v8, s[16:19], s55 offen offset:2048 sc1
    s_add_u32 s55, s55, 4096
    s_waitcnt vmcnt(7) lgkmcnt(5)
    v_mfma_f32_16x16x32_bf16 v[32:35], v[52:55], v[124:127], v[32:35]
    ds_read_b128 v[92:95], v10 offset:41984
    v_mfma_f32_16x16x32_bf16 v[36:39], v[56:59], v[124:127], v[36:39]
    ds_read_b128 v[96:99], v10 offset:43008
    v_mfma_f32_16x16x32_bf16 v[40:43], v[60:63], v[124:127], v[40:43]
    ds_read_b128 v[100:103], v10 offset:44032
    v_mfma_f32_16x16x32_bf16 v[44:47], v[64:67], v[124:127], v[44:47]
    ds_read_b128 v[104:107], v10 offset:45056
    v_mfma_f32_16x16x32_bf16 v[48:51], v[68:71], v[124:127], v[48:51]
    ds_read_b128 v[108:111], v10 offset:46080
    buffer_load_dwordx4 v[120:123], v8, s[16:19], s55 offen offset:0 sc1
    s_waitcnt vmcnt(7) lgkmcnt(5)
    s_barrier
    v_mfma_f32_16x16x32_bf16 v[32:35], v[72:75], v[128:131], v[32:35]
    ds_read_b128 v[52:55], v10 offset:55296
    v_mfma_f32_16x16x32_bf16 v[36:39], v[76:79], v[128:131], v[36:39]
    ds_read_b128 v[56:59], v10 offset:56320
    v_mfma_f32_16x16x32_bf16 v[40:43], v[80:83], v[128:131], v[40:43]
    ds_read_b128 v[60:63], v10 offset:57344
    v_mfma_f32_16x16x32_bf16 v[44:47], v[84:87], v[128:131], v[44:47]
    ds_read_b128 v[64:67], v10 offset:58368
    v_mfma_f32_16x16x32_bf16 v[48:51], v[88:91], v[128:131], v[48:51]
    ds_read_b128 v[68:71], v10 offset:59392
    buffer_load_dwordx4 v[124:127], v8, s[16:19], s55 offen offset:2048 sc1
    s_add_u32 s55, s55, 4096
    s_waitcnt vmcnt(7) lgkmcnt(5)
    v_mfma_f32_16x16x32_bf16 v[32:35], v[92:95], v[132:135], v[32:35]
    ds_read_b128 v[72:75], v11 offset:0
    v_mfma_f32_16x16x32_bf16 v[36:39], v[96:99], v[132:135], v[36:39]
    ds_read_b128 v[76:79], v11 offset:1024
    v_mfma_f32_16x16x32_bf16 v[40:43], v[100:103], v[132:135], v[40:43]
    ds_read_b128 v[80:83], v11 offset:2048
    v_mfma_f32_16x16x32_bf16 v[44:47], v[104:107], v[132:135], v[44:47]
    ds_read_b128 v[84:87], v11 offset:3072
    v_mfma_f32_16x16x32_bf16 v[48:51], v[108:111], v[132:135], v[48:51]
    ds_read_b128 v[88:91], v11 offset:4096
    buffer_load_dwordx4 v[128:131], v8, s[16:19], s55 offen offset:0 sc1
    s_waitcnt vmcnt(7) lgkmcnt(5)
    v_mfma_f32_16x16x32_bf16 v[32:35], v[52:55], v[136:139], v[32:35]
    ds_read_b128 v[92:95], v9 offset:61440
    v_mfma_f32_16x16x32_bf16 v[36:39], v[56:59], v[136:139], v[36:39]
    ds_read_b128 v[96:99], v9 offset:62464
    v_mfma_f32_16x16x32_bf16 v[40:43], v[60:63], v[136:139], v[40:43]
    ds_read_b128 v[100:103], v9 offset:63488
    v_mfma_f32_16x16x32_bf16 v[44:47], v[64:67], v[136:139], v[44:47]
    ds_read_b128 v[104:107], v9 offset:64512
    v_mfma_f32_16x16x32_bf16 v[48:51], v[68:71], v[136:139], v[48:51]
    ds_read_b128 v[108:111], v10 offset:0
    buffer_load_dwordx4 v[132:135], v8, s[16:19], s55 offen offset:2048 sc1
    s_add_u32 s55, s55, 4096
    s_waitcnt vmcnt(7) lgkmcnt(5)
    s_barrier
    v_mfma_f32_16x16x32_bf16 v[32:35], v[72:75], v[140:143], v[32:35]
    ds_read_b128 v[52:55], v9 offset:0
    v_mfma_f32_16x16x32_bf16 v[36:39], v[76:79], v[140:143], v[36:39]
    ds_read_b128 v[56:59], v9 offset:1024
    v_mfma_f32_16x16x32_bf16 v[40:43], v[80:83], v[140:143], v[40:43]
    ds_read_b128 v[60:63], v9 offset:2048
    v_mfma_f32_16x16x32_bf16 v[44:47], v[84:87], v[140:143], v[44:47]
    ds_read_b128 v[64:67], v9 offset:3072
    v_mfma_f32_16x16x32_bf16 v[48:51], v[88:91], v[140:143], v[48:51]
    ds_read_b128 v[68:71], v9 offset:4096
    s_waitcnt vmcnt(6) lgkmcnt(5)
    v_mfma_f32_16x16x32_bf16 v[32:35], v[92:95], v[144:147], v[32:35]
    ds_read_b128 v[72:75], v9 offset:10240
    v_mfma_f32_16x16x32_bf16 v[36:39], v[96:99], v[144:147], v[36:39]
    ds_read_b128 v[76:79], v9 offset:11264
    v_mfma_f32_16x16x32_bf16 v[40:43], v[100:103], v[144:147], v[40:43]
    ds_read_b128 v[80:83], v9 offset:12288
    v_mfma_f32_16x16x32_bf16 v[44:47], v[104:107], v[144:147], v[44:47]
    ds_read_b128 v[84:87], v9 offset:13312
    v_mfma_f32_16x16x32_bf16 v[48:51], v[108:111], v[144:147], v[48:51]
    ds_read_b128 v[88:91], v9 offset:14336
    s_waitcnt vmcnt(5) lgkmcnt(5)
    v_mfma_f32_16x16x32_bf16 v[32:35], v[52:55], v[112:115], v[32:35]
    ds_read_b128 v[92:95], v9 offset:20480
    v_mfma_f32_16x16x32_bf16 v[36:39], v[56:59], v[112:115], v[36:39]
    ds_read_b128 v[96:99], v9 offset:21504
    v_mfma_f32_16x16x32_bf16 v[40:43], v[60:63], v[112:115], v[40:43]
    ds_read_b128 v[100:103], v9 offset:22528
    v_mfma_f32_16x16x32_bf16 v[44:47], v[64:67], v[112:115], v[44:47]
    ds_read_b128 v[104:107], v9 offset:23552
    v_mfma_f32_16x16x32_bf16 v[48:51], v[68:71], v[112:115], v[48:51]
    ds_read_b128 v[108:111], v9 offset:24576
    s_waitcnt vmcnt(4) lgkmcnt(5)
    s_barrier
    v_mfma_f32_16x16x32_bf16 v[32:35], v[72:75], v[116:119], v[32:35]
    ds_read_b128 v[52:55], v11 offset:12288
    v_mfma_f32_16x16x32_bf16 v[36:39], v[76:79], v[116:119], v[36:39]
    ds_read_b128 v[56:59], v11 offset:13312
    v_mfma_f32_16x16x32_bf16 v[40:43], v[80:83], v[116:119], v[40:43]
    ds_read_b128 v[60:63], v11 offset:14336
    v_mfma_f32_16x16x32_bf16 v[44:47], v[84:87], v[116:119], v[44:47]
    ds_read_b128 v[64:67], v11 offset:15360
    v_mfma_f32_16x16x32_bf16 v[48:51], v[88:91], v[116:119], v[48:51]
    ds_read_b128 v[68:71], v11 offset:16384
    s_waitcnt vmcnt(3) lgkmcnt(5)
    v_mfma_f32_16x16x32_bf16 v[32:35], v[92:95], v[120:123], v[32:35]
    ds_read_b128 v[72:75], v11 offset:22528
    v_mfma_f32_16x16x32_bf16 v[36:39], v[96:99], v[120:123], v[36:39]
    ds_read_b128 v[76:79], v11 offset:23552
    v_mfma_f32_16x16x32_bf16 v[40:43], v[100:103], v[120:123], v[40:43]
    ds_read_b128 v[80:83], v11 offset:24576
    v_mfma_f32_16x16x32_bf16 v[44:47], v[104:107], v[120:123], v[44:47]
    ds_read_b128 v[84:87], v11 offset:25600
    v_mfma_f32_16x16x32_bf16 v[48:51], v[108:111], v[120:123], v[48:51]
    ds_read_b128 v[88:91], v11 offset:26624
    s_waitcnt vmcnt(2) lgkmcnt(5)
    v_mfma_f32_16x16x32_bf16 v[32:35], v[52:55], v[124:127], v[32:35]
    ds_read_b128 v[92:95], v10 offset:11264
    v_mfma_f32_16x16x32_bf16 v[36:39], v[56:59], v[124:127], v[36:39]
    ds_read_b128 v[96:99], v10 offset:12288
    v_mfma_f32_16x16x32_bf16 v[40:43], v[60:63], v[124:127], v[40:43]
    ds_read_b128 v[100:103], v10 offset:13312
    v_mfma_f32_16x16x32_bf16 v[44:47], v[64:67], v[124:127], v[44:47]
    ds_read_b128 v[104:107], v10 offset:14336
    v_mfma_f32_16x16x32_bf16 v[48:51], v[68:71], v[124:127], v[48:51]
    ds_read_b128 v[108:111], v10 offset:15360
    s_waitcnt vmcnt(1) lgkmcnt(5)
    v_mfma_f32_16x16x32_bf16 v[32:35], v[72:75], v[128:131], v[32:35]
    v_mfma_f32_16x16x32_bf16 v[36:39], v[76:79], v[128:131], v[36:39]
    v_mfma_f32_16x16x32_bf16 v[40:43], v[80:83], v[128:131], v[40:43]
    v_mfma_f32_16x16x32_bf16 v[44:47], v[84:87], v[128:131], v[44:47]
    v_mfma_f32_16x16x32_bf16 v[48:51], v[88:91], v[128:131], v[48:51]
    s_waitcnt vmcnt(0) lgkmcnt(0)
    v_mfma_f32_16x16x32_bf16 v[32:35], v[92:95], v[132:135], v[32:35]
    v_mfma_f32_16x16x32_bf16 v[36:39], v[96:99], v[132:135], v[36:39]
    v_mfma_f32_16x16x32_bf16 v[40:43], v[100:103], v[132:135], v[40:43]
    v_mfma_f32_16x16x32_bf16 v[44:47], v[104:107], v[132:135], v[44:47]
    v_mfma_f32_16x16x32_bf16 v[48:51], v[108:111], v[132:135], v[48:51]
    s_and_b32 s31, s24, 3
    s_mul_i32 s31, s31, 5120
    s_add_u32 s31, s31, 30720
    v_add_u32 v2, s31, v8
    s_nop 4
    ds_write_b128 v2, v[32:35] offset:0
    ds_write_b128 v2, v[36:39] offset:1024
    ds_write_b128 v2, v[40:43] offset:2048
    ds_write_b128 v2, v[44:47] offset:3072
    ds_write_b128 v2, v[48:51] offset:4096
    s_waitcnt lgkmcnt(0)
    s_barrier
L_kf_fin:
L_kf_end:
    s_endpgm
.section .rodata,"a"
.p2align 6
.amdhsa_kernel fused_kernel
  .amdhsa_next_free_vgpr 168
  .amdhsa_next_free_sgpr 100
  .amdhsa_accum_offset 168
  .amdhsa_group_segment_fixed_size 0
  .amdhsa_kernarg_size 72
  .amdhsa_user_sgpr_count 2
  .amdhsa_user_sgpr_kernarg_segment_ptr 1
  .amdhsa_system_sgpr_workgroup_id_x 1
.end_amdhsa_kernel
```
